```python
import torch

def _softmax(x, axis=-1):
    return torch.softmax(x, dim=axis)
def _gelu(x):
    return torch.nn.functional.gelu(x, approximate="tanh")
def _silu(x):
    return torch.nn.functional.silu(x)
def _sigmoid(x):
    return torch.sigmoid(x)
def _layernorm(x, axis=-1, eps=1e-5):
    m = x.mean(dim=axis, keepdim=True)
    v = x.var(dim=axis, keepdim=True, unbiased=False)
    return (x - m) / torch.sqrt(v + eps)
def _scatter_add(tgt, idx, src, axis=0):
    return tgt.clone().index_add_(axis, idx, src)
def _segment_sum(src, seg, n):
    out = torch.zeros((n,) + src.shape[1:], dtype=src.dtype)
    return out.index_add_(0, seg, src)
def _pad(x, pw):
    flat = tuple(v for pair in reversed(pw) for v in pair)
    return torch.nn.functional.pad(x, flat)

kernel_name = 'sequential_preLN__ssm_conv_h3__mixer_channel_mlp__prompt'

def setup_inputs():

    _w = (lambda a: (lambda t: t.to(torch.bfloat16) if t.is_floating_point() else t)(torch.as_tensor(a)))
    def _A_setup():
        B, S, D = 1, 2048, 448
        ks = 4
        return {
            "q": _w((lambda *s: torch.randn(*s, dtype=torch.bfloat16) * 0.05)(B, S, D)),
            "k": _w((lambda *s: torch.randn(*s, dtype=torch.bfloat16) * 0.2)(B, S, D)),
            "v": _w((lambda *s: torch.randn(*s, dtype=torch.bfloat16) * 0.2)(B, S, D)),
            "shift_k": _w((lambda *s: torch.randn(*s, dtype=torch.bfloat16) * 0.2)(D, ks) * 0.5),
            "ssm_k": _w((lambda *s: torch.randn(*s, dtype=torch.bfloat16) * 0.8)(D, S) * (1.0 / S ** 0.5)),
            "ssm_D": _w((lambda *s: torch.randn(*s, dtype=torch.bfloat16) * 0.2)(D)),
        }
    _A_in = _A_setup()

    def _B_setup():
        B, S, D, F = 1, 2048, 448, 1792
        return {
            "x": _w((lambda *s: torch.randn(*s, dtype=torch.bfloat16) * 0.05)(B, S, D)),
            "w1": _w((lambda *s: torch.randn(*s, dtype=torch.bfloat16) * 0.8)(D, F) * (D ** -0.5)),
            "b1": _w((lambda *s: torch.randn(*s, dtype=torch.bfloat16) * 0.4)(F)),
            "w2": _w((lambda *s: torch.randn(*s, dtype=torch.bfloat16) * 0.05)(F, D) * (F ** -0.5)),
            "b2": _w((lambda *s: torch.randn(*s, dtype=torch.bfloat16) * 0.05)(D)),
        }
    _B_in = _B_setup()

    return {
        "A_q": _A_in["q"],
        "A_k": _A_in["k"],
        "A_v": _A_in["v"],
        "A_shift_k": _A_in["shift_k"],
        "A_ssm_k": _A_in["ssm_k"],
        "A_ssm_D": _A_in["ssm_D"],
        "B_x": _B_in["x"],
        "B_w1": _B_in["w1"],
        "B_b1": _B_in["b1"],
        "B_w2": _B_in["w2"],
        "B_b2": _B_in["b2"],
    }

def reference(A_q, A_k, A_v, A_shift_k, A_ssm_k, A_ssm_D, B_x, B_w1, B_b1, B_w2, B_b2):
    def _A_ref(q, k, v, shift_k, ssm_k, ssm_D):
        B, S, D = q.shape
        ks = shift_k.shape[-1]
        k_pad = _pad(k, ((0, 0), (ks - 1, 0), (0, 0)))
        k_shift = torch.zeros_like(k)
        for t in range(ks):
            k_shift = k_shift + k_pad[:, t:t + S, :] * shift_k[:, ks - 1 - t][None, None, :]
        kv = k_shift * v
        L = 2 * S
        kv_pad = _pad(kv, ((0, 0), (0, S), (0, 0)))
        kf_pad = _pad(ssm_k, ((0, 0), (0, S)))
        kv_f = (lambda x, axes=(-2,-1): torch.fft.rfft2(x.float(), dim=axes))(kv_pad[:, None, :, :], axes=(1, 2))
        kf_f = (lambda x, axes=(-2,-1): torch.fft.rfft2(x.float(), dim=axes))(kf_pad[:, None, :], axes=(1, 2))
        kf_f = (lambda x, *d: x.permute(*d))(kf_f, 1, 2, 0)
        y_f = kv_f * kf_f[None, :, :, :]
        y = (lambda x, s, axes=(-2,-1): torch.fft.irfft2(x, s=s, dim=axes).to(torch.bfloat16))(y_f, (1, L), axes=(1, 2))[:, 0, :S, :]
        y = y + kv * ssm_D[None, None, :]
        return q * y

    def _B_ref(x, w1, b1, w2, b2):
        y = _layernorm(x, axis=-1)
        h = _gelu(torch.einsum("bsd,df->bsf", y, w1) + b1)
        return torch.einsum("bsf,fd->bsd", h, w2) + b2

    x = A_q
    h = x + _A_ref(_layernorm(x, axis=-1), A_k, A_v, A_shift_k, A_ssm_k, A_ssm_D)
    h2 = h + _B_ref(_layernorm(h, axis=-1), B_w1, B_b1, B_w2, B_b2)
    return h2
```

```asm
; @launch grid=(253,1,1) block=(512,1,1) lds=141376
.amdgcn_target "amdgcn-amd-amdhsa--gfx950"
.text
.globl sequential_preLN__ssm_conv_h3__mixer_channel_mlp__prompt_kernel
.p2align 8
.type sequential_preLN__ssm_conv_h3__mixer_channel_mlp__prompt_kernel,@function
sequential_preLN__ssm_conv_h3__mixer_channel_mlp__prompt_kernel:
    v_lshrrev_b32 v2, 6, v0
    v_and_b32 v1, 63, v0
    v_readfirstlane_b32 s3, v2
    s_cmp_ge_u32 s2, 224
    s_cbranch_scc0 MAIN
    s_cmp_eq_u32 s3, 7
    s_cbranch_scc0 HELPER
    s_getpc_b64 s[64:65]
PCBASE:
    s_mov_b32 s66, CODE_END-PCBASE
    s_mov_b32 s67, 0x20000
    v_lshlrev_b32 v2, 7, v1
    s_movk_i32 s4, 0x2000
    s_movk_i32 s5, 0x4000
    buffer_load_dword v4, v2, s[64:67], 0 offen
    buffer_load_dword v5, v2, s[64:67], s4 offen
    buffer_load_dword v6, v2, s[64:67], s5 offen
    s_movk_i32 s4, 0x6000
    buffer_load_dword v7, v2, s[64:67], s4 offen
    s_endpgm
MAIN:
    s_cmp_ge_u32 s3, 4
    s_cbranch_scc1 P_AUX
    s_load_dwordx2 s[12:13], s[0:1], 8
    s_load_dwordx2 s[16:17], s[0:1], 16
    s_load_dwordx2 s[20:21], s[0:1], 24
    s_lshr_b32 s5, s2, 3
    s_mul_i32 s75, s5, 9363
    s_lshr_b32 s75, s75, 16
    s_and_b32 s6, s2, 7
    s_lshl_b32 s68, s6, 2
    s_add_u32 s68, s68, s75
    s_mul_i32 s75, s75, 7
    s_sub_u32 s69, s5, s75
    s_mul_i32 s8, s68, 57344
    s_lshl_b32 s9, s69, 7
    s_add_u32 s8, s8, s9
    s_mul_i32 s4, s3, 14336
    s_add_u32 s8, s8, s4
    s_mul_i32 s4, s3, 3072
    s_add_u32 m0, s4, 84992
    s_mov_b32 s14, 1835008
    s_mov_b32 s15, 0x20000
    s_mov_b32 s18, 1835008
    s_mov_b32 s19, 0x20000
    s_mov_b32 s22, 3584
    s_mov_b32 s23, 0x20000
    v_and_b32 v2, 7, v1
    v_lshrrev_b32 v3, 3, v1
    v_lshl_add_u32 v2, v2, 4, s8
    v_mul_u32_u24 v3, 896, v3
    v_add_u32 v4, v2, v3
    v_lshl_add_u32 v8, v3, 1, v2
    s_lshl_b32 s4, s9, 2
    v_lshl_add_u32 v5, v1, 3, s4
    s_movk_i32 s4, 7168
    s_waitcnt lgkmcnt(0)
    buffer_load_dwordx2 v[6:7], v5, s[20:23], 0 offen
    buffer_load_dwordx4 v4, s[12:15], 0 offen nt lds
    s_add_u32 m0, m0, 1024
    buffer_load_dwordx4 v[52:55], v8, s[16:19], 0 offen nt
    buffer_load_dwordx4 v4, s[12:15], s4 offen nt lds
    buffer_load_dwordx4 v[56:59], v8, s[16:19], 0 offen offset:896 nt
    v_subrev_u32 v4, 7168, v4
    v_cmp_lt_u32 vcc, 39, v1
    s_sub_u32 m0, m0, 2048
    s_mul_i32 s72, s6, 28
    s_add_u32 s72, s72, s5
    v_cndmask_b32 v4, -1, v4, vcc
    buffer_load_dwordx4 v4, s[12:15], 0 offen nt lds
    s_load_dwordx2 s[56:57], s[0:1], 104
    s_load_dwordx2 s[52:53], s[0:1], 96
    s_load_dwordx2 s[28:29], s[0:1], 40
    s_load_dwordx2 s[36:37], s[0:1], 64
    s_load_dwordx2 s[44:45], s[0:1], 80
    s_load_dwordx2 s[48:49], s[0:1], 88
    s_branch P_DONE
P_AUX:
    s_cmp_lt_u32 s3, 6
    s_cselect_b32 s6, 0, 32
    s_load_dwordx2 s[12:13], s[0:1], s6
    s_load_dwordx2 s[32:33], s[0:1], 56
    s_load_dwordx2 s[56:57], s[0:1], 104
    s_load_dwordx2 s[52:53], s[0:1], 96
    s_load_dwordx2 s[28:29], s[0:1], 40
    s_load_dwordx2 s[36:37], s[0:1], 64
    s_load_dwordx2 s[44:45], s[0:1], 80
    s_load_dwordx2 s[48:49], s[0:1], 88
    s_mov_b32 s14, 1835008
    s_mov_b32 s15, 0x20000
    s_mov_b32 s34, 1605632
    s_mov_b32 s35, 0x20000
    s_lshr_b32 s5, s2, 3
    s_mul_i32 s75, s5, 9363
    s_lshr_b32 s75, s75, 16
    s_and_b32 s6, s2, 7
    s_lshl_b32 s68, s6, 2
    s_add_u32 s68, s68, s75
    s_mul_i32 s75, s75, 7
    s_sub_u32 s69, s5, s75
    s_mul_i32 s8, s68, 57344
    s_lshl_b32 s9, s69, 7
    s_add_u32 s8, s8, s9
    s_mul_i32 s72, s6, 28
    s_add_u32 s72, s72, s5
    s_and_b32 s7, s3, 1
    s_mul_i32 s4, s7, 28
    s_add_u32 s4, s4, s5
    s_lshl_b32 s6, s6, 5
    s_add_u32 s6, s6, s4
    s_cmp_lt_u32 s4, 32
    s_cselect_b32 s11, s6, 256
    s_lshl_b32 s10, s72, 13
    s_lshl_b32 s4, s7, 12
    s_add_u32 s10, s10, s4
    s_add_u32 s27, s4, 75776
    s_mul_i32 s5, s7, 8320
    s_add_u32 s5, s5, 4192
    s_lshl_b32 s4, s7, 6
    s_add_u32 s24, s8, s4
    s_mul_i32 s25, s11, 7168
    s_cmp_lt_u32 s3, 6
    s_cselect_b32 s24, s24, s10
    s_cselect_b32 m0, s27, s5
    s_cselect_b32 s26, 896, 64
    s_movk_i32 s10, 1024
    s_cselect_b32 s10, 14336, s10
    s_cselect_b32 s11, s11, 256
    v_and_b32 v2, 3, v1
    v_lshrrev_b32 v3, 2, v1
    v_mul_u32_u24 v4, s26, v3
    v_lshl_add_u32 v4, v2, 4, v4
    v_add_u32 v4, s24, v4
    v_and_b32 v2, 7, v1
    v_lshrrev_b32 v3, 3, v1
    v_mul_u32_u24 v8, 896, v3
    v_lshl_add_u32 v8, v2, 4, v8
    v_add_u32 v8, s25, v8
    s_mov_b32 s5, 0
    s_waitcnt lgkmcnt(0)
    buffer_load_dwordx4 v4, s[12:15], s5 offen nt lds
    s_add_u32 m0, m0, 1024
    s_add_u32 s5, s5, s10
    buffer_load_dwordx4 v4, s[12:15], s5 offen nt lds
    s_add_u32 m0, m0, 1024
    s_add_u32 s5, s5, s10
    buffer_load_dwordx4 v4, s[12:15], s5 offen nt lds
    s_add_u32 m0, m0, 1024
    s_add_u32 s5, s5, s10
    buffer_load_dwordx4 v4, s[12:15], s5 offen nt lds
    s_cmp_lt_u32 s3, 6
    s_cbranch_scc0 P_W1
    s_cmp_lt_u32 s11, 256
    s_cbranch_scc0 P_DONE
    buffer_load_dwordx4 v[32:35], v8, s[12:15], 0 offen offset:0 nt
    buffer_load_dwordx4 v[36:39], v8, s[12:15], 0 offen offset:128 nt
    buffer_load_dwordx4 v[40:43], v8, s[12:15], 0 offen offset:256 nt
    buffer_load_dwordx4 v[44:47], v8, s[12:15], 0 offen offset:384 nt
    buffer_load_dwordx4 v[48:51], v8, s[12:15], 0 offen offset:512 nt
    buffer_load_dwordx4 v[52:55], v8, s[12:15], 0 offen offset:640 nt
    buffer_load_dwordx4 v[56:59], v8, s[12:15], 0 offen offset:768 nt
    s_branch P_DONE
P_W1:
    s_lshr_b32 s4, s72, 2
    s_and_b32 s5, s72, 3
    s_mul_i32 s5, s5, 7
    s_add_u32 s5, s5, s7
    s_mul_i32 s25, s4, 28
    s_add_u32 s25, s25, s5
    s_mul_i32 s5, s5, 57344
    s_lshl_b32 s4, s4, 6
    s_add_u32 s5, s5, s4
    v_and_b32 v2, 3, v1
    v_lshrrev_b32 v3, 2, v1
    v_mul_u32_u24 v8, 3584, v3
    v_lshl_add_u32 v8, v2, 4, v8
    s_lshl_b32 s4, s7, 12
    s_add_u32 m0, s4, 50432
    buffer_load_dwordx4 v8, s[32:35], s5 offen nt lds
    s_add_u32 m0, m0, 1024
    s_add_u32 s5, s5, 114688
    buffer_load_dwordx4 v8, s[32:35], s5 offen nt lds
    s_add_u32 m0, m0, 1024
    s_add_u32 s5, s5, 114688
    buffer_load_dwordx4 v8, s[32:35], s5 offen nt lds
    s_add_u32 m0, m0, 1024
    s_add_u32 s5, s5, 114688
    s_cmp_eq_u32 s7, 0
    s_cbranch_scc0 P_DONE
    buffer_load_dwordx4 v8, s[32:35], s5 offen nt lds
P_DONE:
    s_mov_b32 s73, s68
    s_mov_b32 s74, s69
    s_mov_b32 s60, s3
    s_and_b32 s4, s69, 1
    s_lshl_b32 s4, s4, 2
    s_xor_b32 s61, s60, s4
    s_mov_b32 s58, 268435456
    s_mov_b32 s59, 0x20000
    s_mov_b32 s54, 256
    s_mov_b32 s55, 0x20000
    s_mov_b32 s30, 896
    s_mov_b32 s31, 0x20000
    s_mov_b32 s38, 3584
    s_mov_b32 s39, 0x20000
    s_mov_b32 s46, 896
    s_mov_b32 s47, 0x20000
    s_mov_b32 s50, 1835008
    s_mov_b32 s51, 0x20000
    s_cmp_ge_u32 s3, 4
    s_cbranch_scc0 CRIT1
    v_mov_b32 v60, 0
    v_mov_b32 v61, 0
    v_mov_b32 v62, 0
    v_mov_b32 v63, 0
    v_and_b32 v13, 31, v1
    v_lshlrev_b32 v13, 4, v13
    v_lshrrev_b32 v14, 5, v1
    v_mul_u32_u24 v14, 4608, v14
    v_add_u32 v13, v13, v14
    v_add_u32 v13, 20736, v13
    s_cmp_eq_u32 s3, 5
    s_cbranch_scc0 AZ1
    v_and_b32 v13, 16, v1
    v_add_u32 v13, 139264, v13
AZ1:
    s_cmp_eq_u32 s3, 6
    s_cbranch_scc0 AZ2
    v_bfe_u32 v13, v1, 1, 2
    v_mul_u32_u24 v13, 4160, v13
    v_and_b32 v14, 1, v1
    v_lshl_add_u32 v13, v14, 4, v13
AZ2:
    ds_write_b128 v13, v[60:63]
    s_mov_b32 s76, 0xffff0000
    s_waitcnt lgkmcnt(0)
    s_barrier
    s_cmp_ge_u32 s3, 6
    s_cbranch_scc1 AUXW
    s_branch AUXQ
CRIT1:
    v_lshrrev_b32 v3, 3, v0
    v_and_b32 v2, 7, v1
    s_mov_b32 s76, 0xffff0000
    v_mul_u32_u24 v11, 320, v3
    v_sub_u32 v11, 75456, v11
    v_lshl_add_u32 v11, v2, 4, v11
    v_lshrrev_b32 v2, 4, v1
    v_bfe_u32 v3, v1, 2, 2
    v_lshl_add_u32 v3, v2, 3, v3
    v_mul_u32_u24 v12, 160, v3
    v_and_b32 v3, 3, v1
    v_lshl_add_u32 v12, v3, 3, v12
    s_lshl_b32 s6, s3, 5
    s_add_u32 s6, s6, 65536
    v_add_u32 v12, s6, v12
    v_and_b32 v3, 15, v1
    v_lshlrev_b32 v13, 12, v3
    v_lshl_add_u32 v13, v2, 4, v13
    s_lshl_b32 s6, s69, 18
    s_lshl_b32 s7, s3, 16
    s_add_u32 s6, s6, s7
    s_lshl_b32 s7, s68, 7
    s_sub_u32 s6, s6, s7
    s_add_u32 s6, s6, 69504
    v_add_u32 v13, s6, v13
    s_lshl_b32 s4, s72, 2
    s_waitcnt lgkmcnt(0)
    s_load_dword s70, s[28:29], s4
    v_mov_b32 v14, 139280
    v_mov_b32 v15, 1
    s_lshl_b32 s4, s3, 9
    s_add_u32 s4, s4, 96256
    v_lshl_add_u32 v5, v1, 3, s4
    v_and_b32 v2, 7, v1
    v_lshl_add_u32 v8, v2, 6, s4
    v_lshrrev_b32 v3, 3, v1
    v_lshlrev_b32 v9, 8, v3
    v_lshl_add_u32 v9, v2, 4, v9
    s_mul_i32 s4, s3, 3072
    s_add_u32 s4, s4, 84608
    v_add_u32 v9, s4, v9
    s_waitcnt vmcnt(5)
    ds_write_b64 v5, v[6:7]
    ds_read_b128 v[16:19], v8 offset:0
    ds_read_b128 v[20:23], v8 offset:16
    ds_read_b128 v[24:27], v8 offset:32
    ds_read_b128 v[28:31], v8 offset:48
    s_waitcnt lgkmcnt(0)
    v_lshlrev_b32 v64, 16, v16
    v_and_b32 v72, s76, v16
    v_lshlrev_b32 v80, 16, v17
    v_and_b32 v88, s76, v17
    v_lshlrev_b32 v65, 16, v18
    v_and_b32 v73, s76, v18
    v_lshlrev_b32 v81, 16, v19
    v_and_b32 v89, s76, v19
    v_lshlrev_b32 v66, 16, v20
    v_and_b32 v74, s76, v20
    v_lshlrev_b32 v82, 16, v21
    v_and_b32 v90, s76, v21
    v_lshlrev_b32 v67, 16, v22
    v_and_b32 v75, s76, v22
    v_lshlrev_b32 v83, 16, v23
    v_and_b32 v91, s76, v23
    v_lshlrev_b32 v68, 16, v24
    v_and_b32 v76, s76, v24
    v_lshlrev_b32 v84, 16, v25
    v_and_b32 v92, s76, v25
    v_lshlrev_b32 v69, 16, v26
    v_and_b32 v77, s76, v26
    v_lshlrev_b32 v85, 16, v27
    v_and_b32 v93, s76, v27
    v_lshlrev_b32 v70, 16, v28
    v_and_b32 v78, s76, v28
    v_lshlrev_b32 v86, 16, v29
    v_and_b32 v94, s76, v29
    v_lshlrev_b32 v71, 16, v30
    v_and_b32 v79, s76, v30
    v_lshlrev_b32 v87, 16, v31
    v_and_b32 v95, s76, v31
    s_barrier
    s_waitcnt vmcnt(0)
    ds_read_b128 v[32:35], v9 offset:0
    ds_read_b128 v[36:39], v9 offset:128
    ds_read_b128 v[40:43], v9 offset:256
    ds_read_b128 v[44:47], v9 offset:384
    ds_read_b128 v[48:51], v9 offset:512
    v_lshlrev_b32 v106, 16, v52
    v_and_b32 v107, s76, v52
    v_lshlrev_b32 v108, 16, v56
    v_and_b32 v109, s76, v56
    v_lshlrev_b32 v26, 16, v53
    v_and_b32 v27, s76, v53
    v_lshlrev_b32 v28, 16, v57
    v_and_b32 v29, s76, v57
    s_waitcnt lgkmcnt(0)
    v_lshlrev_b32 v96, 16, v32
    v_and_b32 v97, s76, v32
    v_lshlrev_b32 v98, 16, v36
    v_and_b32 v99, s76, v36
    v_lshlrev_b32 v100, 16, v40
    v_and_b32 v101, s76, v40
    v_lshlrev_b32 v102, 16, v44
    v_and_b32 v103, s76, v44
    v_lshlrev_b32 v104, 16, v48
    v_and_b32 v105, s76, v48
    v_lshlrev_b32 v16, 16, v33
    v_and_b32 v17, s76, v33
    v_lshlrev_b32 v18, 16, v37
    v_and_b32 v19, s76, v37
    v_lshlrev_b32 v20, 16, v41
    v_and_b32 v21, s76, v41
    v_lshlrev_b32 v22, 16, v45
    v_and_b32 v23, s76, v45
    v_lshlrev_b32 v24, 16, v49
    v_and_b32 v25, s76, v49
    v_pk_mul_f32 v[110:111], v[64:65], v[102:103]
    v_pk_mul_f32 v[112:113], v[64:65], v[104:105]
    v_pk_mul_f32 v[60:61], v[66:67], v[22:23]
    v_pk_mul_f32 v[62:63], v[66:67], v[24:25]
    v_pk_fma_f32 v[110:111], v[72:73], v[100:101], v[110:111]
    v_pk_fma_f32 v[112:113], v[72:73], v[102:103], v[112:113]
    v_pk_fma_f32 v[60:61], v[74:75], v[20:21], v[60:61]
    v_pk_fma_f32 v[62:63], v[74:75], v[22:23], v[62:63]
    v_pk_fma_f32 v[110:111], v[80:81], v[98:99], v[110:111]
    v_pk_fma_f32 v[112:113], v[80:81], v[100:101], v[112:113]
    v_pk_fma_f32 v[60:61], v[82:83], v[18:19], v[60:61]
    v_pk_fma_f32 v[62:63], v[82:83], v[20:21], v[62:63]
    v_pk_fma_f32 v[110:111], v[88:89], v[96:97], v[110:111]
    v_pk_fma_f32 v[112:113], v[88:89], v[98:99], v[112:113]
    v_pk_fma_f32 v[60:61], v[90:91], v[16:17], v[60:61]
    v_pk_fma_f32 v[62:63], v[90:91], v[18:19], v[62:63]
    v_pk_mul_f32 v[110:111], v[110:111], v[106:107]
    v_pk_mul_f32 v[112:113], v[112:113], v[108:109]
    v_pk_mul_f32 v[60:61], v[60:61], v[26:27]
    v_pk_mul_f32 v[62:63], v[62:63], v[28:29]
    v_cvt_pk_bf16_f32 v116, v110, v111
    v_cvt_pk_bf16_f32 v120, v112, v113
    v_cvt_pk_bf16_f32 v117, v60, v61
    v_cvt_pk_bf16_f32 v121, v62, v63
    v_lshlrev_b32 v96, 16, v34
    v_and_b32 v97, s76, v34
    v_lshlrev_b32 v98, 16, v38
    v_and_b32 v99, s76, v38
    v_lshlrev_b32 v100, 16, v42
    v_and_b32 v101, s76, v42
    v_lshlrev_b32 v102, 16, v46
    v_and_b32 v103, s76, v46
    v_lshlrev_b32 v104, 16, v50
    v_and_b32 v105, s76, v50
    v_lshlrev_b32 v106, 16, v54
    v_and_b32 v107, s76, v54
    v_lshlrev_b32 v108, 16, v58
    v_and_b32 v109, s76, v58
    v_lshlrev_b32 v16, 16, v35
    v_and_b32 v17, s76, v35
    v_lshlrev_b32 v18, 16, v39
    v_and_b32 v19, s76, v39
    v_lshlrev_b32 v20, 16, v43
    v_and_b32 v21, s76, v43
    v_lshlrev_b32 v22, 16, v47
    v_and_b32 v23, s76, v47
    v_lshlrev_b32 v24, 16, v51
    v_and_b32 v25, s76, v51
    v_lshlrev_b32 v26, 16, v55
    v_and_b32 v27, s76, v55
    v_lshlrev_b32 v28, 16, v59
    v_and_b32 v29, s76, v59
    v_pk_mul_f32 v[110:111], v[68:69], v[102:103]
    v_pk_mul_f32 v[112:113], v[68:69], v[104:105]
    v_pk_mul_f32 v[60:61], v[70:71], v[22:23]
    v_pk_mul_f32 v[62:63], v[70:71], v[24:25]
    v_pk_fma_f32 v[110:111], v[76:77], v[100:101], v[110:111]
    v_pk_fma_f32 v[112:113], v[76:77], v[102:103], v[112:113]
    v_pk_fma_f32 v[60:61], v[78:79], v[20:21], v[60:61]
    v_pk_fma_f32 v[62:63], v[78:79], v[22:23], v[62:63]
    v_pk_fma_f32 v[110:111], v[84:85], v[98:99], v[110:111]
    v_pk_fma_f32 v[112:113], v[84:85], v[100:101], v[112:113]
    v_pk_fma_f32 v[60:61], v[86:87], v[18:19], v[60:61]
    v_pk_fma_f32 v[62:63], v[86:87], v[20:21], v[62:63]
    v_pk_fma_f32 v[110:111], v[92:93], v[96:97], v[110:111]
    v_pk_fma_f32 v[112:113], v[92:93], v[98:99], v[112:113]
    v_pk_fma_f32 v[60:61], v[94:95], v[16:17], v[60:61]
    v_pk_fma_f32 v[62:63], v[94:95], v[18:19], v[62:63]
    v_pk_mul_f32 v[110:111], v[110:111], v[106:107]
    v_pk_mul_f32 v[112:113], v[112:113], v[108:109]
    v_pk_mul_f32 v[60:61], v[60:61], v[26:27]
    v_pk_mul_f32 v[62:63], v[62:63], v[28:29]
    v_cvt_pk_bf16_f32 v118, v110, v111
    v_cvt_pk_bf16_f32 v122, v112, v113
    v_cvt_pk_bf16_f32 v119, v60, v61
    v_cvt_pk_bf16_f32 v123, v62, v63
    ds_write_b128 v11, v[116:119] offset:160
    ds_write_b128 v11, v[120:123]
    s_mov_b64 exec, 1
    ds_add_u32 v14, v15
    s_mov_b64 exec, -1
    s_mov_b32 s77, 262144
SPIN_1:
    ds_read_b32 v15, v14
    s_waitcnt lgkmcnt(0)
    v_readfirstlane_b32 s75, v15
    s_cmp_ge_u32 s75, 4
    s_cbranch_scc1 SPINOK_2
    s_sub_u32 s77, s77, 1
    s_cbranch_scc0 SPIN_1
SPINOK_2:
    ds_read_b64_tr_b16 v[16:17], v12 offset:0
    ds_read_b64_tr_b16 v[18:19], v12 offset:640
    ds_read_b64_tr_b16 v[20:21], v12 offset:5120
    ds_read_b64_tr_b16 v[22:23], v12 offset:5760
    s_waitcnt lgkmcnt(2)
    buffer_store_dwordx4 v[16:19], v13, s[56:59], 0 offen sc1
    s_waitcnt lgkmcnt(0)
    buffer_store_dwordx4 v[20:23], v13, s[56:59], 0 offen offset:64 sc1
    s_lshr_b32 s6, s3, 1
    s_and_b32 s7, s3, 1
    v_and_b32 v2, 15, v1
    v_lshrrev_b32 v3, 4, v1
    v_add_u32 v4, 25, v2
    v_lshrrev_b32 v4, 1, v4
    v_lshlrev_b32 v5, 2, v3
    v_sub_u32 v4, v4, v5
    v_lshlrev_b32 v4, 2, v4
    v_and_b32 v5, 1, v2
    v_mul_u32_u24 v5, 4160, v5
    v_add_u32 v4, v4, v5
    s_mul_i32 s75, s6, 8320
    s_lshl_b32 s4, s7, 8
    s_add_u32 s75, s75, s4
    v_add_u32 v24, s75, v4
    v_add_u32 v25, 1024, v24
    v_add_u32 v26, 2048, v24
    v_add_u32 v27, 3072, v24
    v_lshlrev_b32 v4, 5, v2
    v_lshl_add_u32 v4, v3, 4, v4
    s_mul_i32 s75, s6, 4608
    s_add_u32 s75, s75, s4
    s_add_u32 s75, s75, 17168
    v_sub_u32 v28, s75, v4
    s_lshl_b32 s4, s70, 16
    s_and_b32 s5, s70, s76
    s_cmp_eq_u32 s6, 0
    s_cselect_b32 s70, s4, s5
    s_mov_b32 s71, s70
    s_load_dword s67, s[52:53], 0
    s_lshl_b32 s6, s69, 8
    s_lshl_b32 s7, s69, 9
    s_add_u32 s7, s7, 2048
    s_waitcnt vmcnt(0) lgkmcnt(0)
    s_mov_b32 s77, 262144
INIT_3:
    s_cmp_lg_u32 s67, 0
    s_cbranch_scc1 INITOK_4
    v_mov_b32 v2, 0
    buffer_load_dword v3, v2, s[52:55], 0 offen sc1
    s_waitcnt vmcnt(0)
    v_readfirstlane_b32 s67, v3
    s_sub_u32 s77, s77, 1
    s_cbranch_scc0 INIT_3
INITOK_4:
    v_mov_b32 v2, 139264
    v_mov_b32 v3, 1
    s_mov_b64 exec, 1
    ds_add_rtn_u32 v3, v2, v3
    s_waitcnt lgkmcnt(0)
    s_mov_b64 exec, -1
    v_readfirstlane_b32 s75, v3
    s_cmp_lg_u32 s75, 3
    s_cbranch_scc1 C_S1_DONE
    s_mov_b32 s75, 1
    s_atomic_add s75, s[56:57], s6 glc
    s_waitcnt lgkmcnt(0)
    s_cmp_lg_u32 s75, 31
    s_cbranch_scc1 ARR_5
    s_mov_b32 s75, 1
    s_atomic_add s75, s[56:57], s7
    s_add_u32 s7, s7, 256
    s_atomic_add s75, s[56:57], s7
    s_waitcnt lgkmcnt(0)
ARR_5:
C_S1_DONE:
    s_and_b32 s7, s3, 1
    s_lshr_b32 s6, s3, 1
    v_lshlrev_b32 v2, 4, v1
    s_lshl_b32 s4, s3, 12
    s_add_u32 s4, s4, 25856
    v_add_u32 v29, s4, v2
    s_xor_b32 s4, s3, 1
    s_lshl_b32 s4, s4, 12
    s_add_u32 s4, s4, 25856
    v_add_u32 v30, s4, v2
    v_and_b32 v5, 15, v1
    v_lshrrev_b32 v6, 4, v1
    v_lshlrev_b32 v7, 5, v5
    v_lshl_add_u32 v7, v6, 3, v7
    s_lshl_b32 s4, s7, 11
    s_lshl_b32 s5, s6, 12
    s_add_u32 s5, s5, s4
    s_add_u32 s5, s5, 42240
    v_add_u32 v8, s5, v7
    s_mul_i32 s5, s6, 4608
    s_sub_u32 s5, s5, s4
    s_add_u32 s5, s5, 19192
    v_sub_u32 v9, s5, v7
    s_lshl_b32 s5, s4, 2
    s_add_u32 s5, s5, 98304
    v_lshlrev_b32 v10, 7, v5
    v_lshrrev_b32 v12, 1, v6
    v_lshl_add_u32 v10, v12, 6, v10
    v_and_b32 v12, 1, v6
    v_lshl_add_u32 v10, v12, 4, v10
    v_add_u32 v10, s5, v10
    v_and_b32 v11, 1, v6
    v_lshlrev_b32 v11, 9, v11
    v_lshl_add_u32 v11, v5, 5, v11
    v_lshrrev_b32 v12, 1, v6
    v_lshl_add_u32 v11, v12, 4, v11
    s_lshl_b32 s5, s72, 13
    s_add_u32 s5, s5, s4
    s_lshl_b32 s4, s6, 12
    s_add_u32 s5, s5, s4
    s_add_u32 s5, s5, 3735552
    v_add_u32 v11, s5, v11
    v_mov_b32 v14, 139272
    v_mov_b32 v15, 1
    s_cmp_lt_u32 s3, 2
    s_cbranch_scc0 C_BAR2
    s_lshr_b32 s6, s72, 5
    s_lshl_b32 s6, s6, 1
    s_and_b32 s5, s2, 1
    s_add_u32 s6, s6, s5
    s_lshl_b32 s6, s6, 8
    s_add_u32 s6, s6, 2048
    v_mov_b32 v3, s6
    s_mul_i32 s4, s3, 4608
    s_add_u32 m0, s4, 16640
    s_lshl_b32 s5, s72, 13
    s_lshl_b32 s4, s3, 12
    s_add_u32 s4, s4, s5
    s_add_u32 s4, s4, 65536
    v_add_u32 v2, s4, v2
    s_mov_b32 s77, 262144
POLL_6:
    buffer_load_dword v4, v3, s[56:59], 0 offen sc1
    s_waitcnt vmcnt(0)
    v_readfirstlane_b32 s75, v4
    s_cmp_ge_u32 s75, 1
    s_cbranch_scc1 POLLD_7
    s_sub_u32 s77, s77, 1
    s_cbranch_scc0 POLL_6
    v_mov_b32 v4, 81
    v_mov_b32 v3, 4
    buffer_store_dword v4, v3, s[52:55], 0 offen
POLLD_7:
    buffer_load_dwordx4 v2, s[56:59], 0 offen offset:0 sc1 lds
    buffer_load_dwordx4 v2, s[56:59], 0 offen offset:1024 sc1 lds
    buffer_load_dwordx4 v2, s[56:59], 0 offen offset:2048 sc1 lds
    buffer_load_dwordx4 v2, s[56:59], 0 offen offset:3072 sc1 lds
    s_waitcnt vmcnt(0)
C_BAR2:
    s_and_b32 s6, s2, 7
    s_lshl_b32 s6, s6, 8
    s_add_u32 s6, s6, 10240
    s_barrier
    ds_read2_b32 a[0:1], v24 offset0:0 offset1:1
    ds_read2_b32 a[2:3], v24 offset0:2 offset1:3
    ds_read_b128 a[32:35], v28 offset:3584
    ds_read_b128 a[36:39], v28 offset:3072
    ds_read_b128 a[40:43], v28 offset:2560
    ds_read_b128 a[44:47], v28 offset:2048
    ds_read_b128 a[48:51], v28 offset:1536
    ds_read_b128 a[52:55], v28 offset:1024
    ds_read_b128 a[56:59], v28 offset:512
    ds_read_b128 a[60:63], v28 offset:0
    ds_read2_b32 a[4:5], v24 offset0:128 offset1:129
    ds_read2_b32 a[6:7], v24 offset0:130 offset1:131
    ds_read2_b32 a[8:9], v25 offset0:0 offset1:1
    ds_read2_b32 a[10:11], v25 offset0:2 offset1:3
    ds_read2_b32 a[12:13], v25 offset0:128 offset1:129
    ds_read2_b32 a[14:15], v25 offset0:130 offset1:131
    ds_read2_b32 a[16:17], v26 offset0:0 offset1:1
    ds_read2_b32 a[18:19], v26 offset0:2 offset1:3
    ds_read2_b32 a[20:21], v26 offset0:128 offset1:129
    ds_read2_b32 a[22:23], v26 offset0:130 offset1:131
    ds_read2_b32 a[24:25], v27 offset0:0 offset1:1
    ds_read2_b32 a[26:27], v27 offset0:2 offset1:3
    ds_read2_b32 a[28:29], v27 offset0:128 offset1:129
    ds_read2_b32 a[30:31], v27 offset0:130 offset1:131
    s_waitcnt lgkmcnt(14)
    v_mfma_f32_16x16x32_bf16 v[64:67], a[0:3], a[32:35], 0
    v_mfma_f32_16x16x32_bf16 v[68:71], a[0:3], a[36:39], 0
    v_mfma_f32_16x16x32_bf16 v[72:75], a[0:3], a[40:43], 0
    v_mfma_f32_16x16x32_bf16 v[76:79], a[0:3], a[44:47], 0
    v_mfma_f32_16x16x32_bf16 v[80:83], a[0:3], a[48:51], 0
    v_mfma_f32_16x16x32_bf16 v[84:87], a[0:3], a[52:55], 0
    v_mfma_f32_16x16x32_bf16 v[88:91], a[0:3], a[56:59], 0
    v_mfma_f32_16x16x32_bf16 v[92:95], a[0:3], a[60:63], 0
    s_waitcnt lgkmcnt(12)
    v_mfma_f32_16x16x32_bf16 v[68:71], a[4:7], a[32:35], v[68:71]
    ds_read2_b32 a[64:65], v24 offset0:16 offset1:17
    v_mfma_f32_16x16x32_bf16 v[72:75], a[4:7], a[36:39], v[72:75]
    ds_read2_b32 a[66:67], v24 offset0:18 offset1:19
    v_mfma_f32_16x16x32_bf16 v[76:79], a[4:7], a[40:43], v[76:79]
    ds_read_b128 a[96:99], v28 offset:3648
    v_mfma_f32_16x16x32_bf16 v[80:83], a[4:7], a[44:47], v[80:83]
    ds_read_b128 a[100:103], v28 offset:3136
    v_mfma_f32_16x16x32_bf16 v[84:87], a[4:7], a[48:51], v[84:87]
    ds_read_b128 a[104:107], v28 offset:2624
    v_mfma_f32_16x16x32_bf16 v[88:91], a[4:7], a[52:55], v[88:91]
    ds_read_b128 a[108:111], v28 offset:2112
    v_mfma_f32_16x16x32_bf16 v[92:95], a[4:7], a[56:59], v[92:95]
    ds_read_b128 a[112:115], v28 offset:1600
    s_waitcnt lgkmcnt(15)
    v_mfma_f32_16x16x32_bf16 v[72:75], a[8:11], a[32:35], v[72:75]
    ds_read_b128 a[116:119], v28 offset:1088
    v_mfma_f32_16x16x32_bf16 v[76:79], a[8:11], a[36:39], v[76:79]
    ds_read_b128 a[120:123], v28 offset:576
    v_mfma_f32_16x16x32_bf16 v[80:83], a[8:11], a[40:43], v[80:83]
    ds_read_b128 a[124:127], v28 offset:64
    v_mfma_f32_16x16x32_bf16 v[84:87], a[8:11], a[44:47], v[84:87]
    ds_read2_b32 a[68:69], v24 offset0:144 offset1:145
    v_mfma_f32_16x16x32_bf16 v[88:91], a[8:11], a[48:51], v[88:91]
    ds_read2_b32 a[70:71], v24 offset0:146 offset1:147
    v_mfma_f32_16x16x32_bf16 v[92:95], a[8:11], a[52:55], v[92:95]
    ds_read2_b32 a[72:73], v25 offset0:16 offset1:17
    s_waitcnt lgkmcnt(15)
    v_mfma_f32_16x16x32_bf16 v[76:79], a[12:15], a[32:35], v[76:79]
    ds_read2_b32 a[74:75], v25 offset0:18 offset1:19
    v_mfma_f32_16x16x32_bf16 v[80:83], a[12:15], a[36:39], v[80:83]
    ds_read2_b32 a[76:77], v25 offset0:144 offset1:145
    v_mfma_f32_16x16x32_bf16 v[84:87], a[12:15], a[40:43], v[84:87]
    ds_read2_b32 a[78:79], v25 offset0:146 offset1:147
    v_mfma_f32_16x16x32_bf16 v[88:91], a[12:15], a[44:47], v[88:91]
    ds_read2_b32 a[80:81], v26 offset0:16 offset1:17
    v_mfma_f32_16x16x32_bf16 v[92:95], a[12:15], a[48:51], v[92:95]
    ds_read2_b32 a[82:83], v26 offset0:18 offset1:19
    s_waitcnt lgkmcnt(15)
    v_mfma_f32_16x16x32_bf16 v[80:83], a[16:19], a[32:35], v[80:83]
    ds_read2_b32 a[84:85], v26 offset0:144 offset1:145
    v_mfma_f32_16x16x32_bf16 v[84:87], a[16:19], a[36:39], v[84:87]
    ds_read2_b32 a[86:87], v26 offset0:146 offset1:147
    v_mfma_f32_16x16x32_bf16 v[88:91], a[16:19], a[40:43], v[88:91]
    ds_read2_b32 a[88:89], v27 offset0:16 offset1:17
    v_mfma_f32_16x16x32_bf16 v[92:95], a[16:19], a[44:47], v[92:95]
    ds_read2_b32 a[90:91], v27 offset0:18 offset1:19
    s_waitcnt lgkmcnt(15)
    v_mfma_f32_16x16x32_bf16 v[84:87], a[20:23], a[32:35], v[84:87]
    ds_read2_b32 a[92:93], v27 offset0:144 offset1:145
    v_mfma_f32_16x16x32_bf16 v[88:91], a[20:23], a[36:39], v[88:91]
    ds_read2_b32 a[94:95], v27 offset0:146 offset1:147
    v_mfma_f32_16x16x32_bf16 v[92:95], a[20:23], a[40:43], v[92:95]
    s_waitcnt lgkmcnt(15)
    v_mfma_f32_16x16x32_bf16 v[88:91], a[24:27], a[32:35], v[88:91]
    v_mfma_f32_16x16x32_bf16 v[92:95], a[24:27], a[36:39], v[92:95]
    s_waitcnt lgkmcnt(15)
    v_mfma_f32_16x16x32_bf16 v[92:95], a[28:31], a[32:35], v[92:95]
    s_waitcnt lgkmcnt(0)
    v_mfma_f32_16x16x32_bf16 v[64:67], a[64:67], a[96:99], v[64:67]
    ds_read2_b32 a[0:1], v24 offset0:32 offset1:33
    v_mfma_f32_16x16x32_bf16 v[68:71], a[64:67], a[100:103], v[68:71]
    ds_read2_b32 a[2:3], v24 offset0:34 offset1:35
    v_mfma_f32_16x16x32_bf16 v[72:75], a[64:67], a[104:107], v[72:75]
    ds_read_b128 a[32:35], v28 offset:3712
    v_mfma_f32_16x16x32_bf16 v[76:79], a[64:67], a[108:111], v[76:79]
    ds_read_b128 a[36:39], v28 offset:3200
    v_mfma_f32_16x16x32_bf16 v[80:83], a[64:67], a[112:115], v[80:83]
    ds_read_b128 a[40:43], v28 offset:2688
    v_mfma_f32_16x16x32_bf16 v[84:87], a[64:67], a[116:119], v[84:87]
    ds_read_b128 a[44:47], v28 offset:2176
    v_mfma_f32_16x16x32_bf16 v[88:91], a[64:67], a[120:123], v[88:91]
    ds_read_b128 a[48:51], v28 offset:1664
    v_mfma_f32_16x16x32_bf16 v[92:95], a[64:67], a[124:127], v[92:95]
    ds_read_b128 a[52:55], v28 offset:1152
    v_mfma_f32_16x16x32_bf16 v[68:71], a[68:71], a[96:99], v[68:71]
    ds_read_b128 a[56:59], v28 offset:640
    v_mfma_f32_16x16x32_bf16 v[72:75], a[68:71], a[100:103], v[72:75]
    ds_read_b128 a[60:63], v28 offset:128
    v_mfma_f32_16x16x32_bf16 v[76:79], a[68:71], a[104:107], v[76:79]
    ds_read2_b32 a[4:5], v24 offset0:160 offset1:161
    v_mfma_f32_16x16x32_bf16 v[80:83], a[68:71], a[108:111], v[80:83]
    ds_read2_b32 a[6:7], v24 offset0:162 offset1:163
    v_mfma_f32_16x16x32_bf16 v[84:87], a[68:71], a[112:115], v[84:87]
    ds_read2_b32 a[8:9], v25 offset0:32 offset1:33
    v_mfma_f32_16x16x32_bf16 v[88:91], a[68:71], a[116:119], v[88:91]
    ds_read2_b32 a[10:11], v25 offset0:34 offset1:35
    v_mfma_f32_16x16x32_bf16 v[92:95], a[68:71], a[120:123], v[92:95]
    ds_read2_b32 a[12:13], v25 offset0:160 offset1:161
    v_mfma_f32_16x16x32_bf16 v[72:75], a[72:75], a[96:99], v[72:75]
    ds_read2_b32 a[14:15], v25 offset0:162 offset1:163
    v_mfma_f32_16x16x32_bf16 v[76:79], a[72:75], a[100:103], v[76:79]
    ds_read2_b32 a[16:17], v26 offset0:32 offset1:33
    v_mfma_f32_16x16x32_bf16 v[80:83], a[72:75], a[104:107], v[80:83]
    ds_read2_b32 a[18:19], v26 offset0:34 offset1:35
    v_mfma_f32_16x16x32_bf16 v[84:87], a[72:75], a[108:111], v[84:87]
    ds_read2_b32 a[20:21], v26 offset0:160 offset1:161
    v_mfma_f32_16x16x32_bf16 v[88:91], a[72:75], a[112:115], v[88:91]
    ds_read2_b32 a[22:23], v26 offset0:162 offset1:163
    v_mfma_f32_16x16x32_bf16 v[92:95], a[72:75], a[116:119], v[92:95]
    ds_read2_b32 a[24:25], v27 offset0:32 offset1:33
    v_mfma_f32_16x16x32_bf16 v[76:79], a[76:79], a[96:99], v[76:79]
    ds_read2_b32 a[26:27], v27 offset0:34 offset1:35
    v_mfma_f32_16x16x32_bf16 v[80:83], a[76:79], a[100:103], v[80:83]
    ds_read2_b32 a[28:29], v27 offset0:160 offset1:161
    v_mfma_f32_16x16x32_bf16 v[84:87], a[76:79], a[104:107], v[84:87]
    ds_read2_b32 a[30:31], v27 offset0:162 offset1:163
    v_mfma_f32_16x16x32_bf16 v[88:91], a[76:79], a[108:111], v[88:91]
    v_mfma_f32_16x16x32_bf16 v[92:95], a[76:79], a[112:115], v[92:95]
    v_mfma_f32_16x16x32_bf16 v[80:83], a[80:83], a[96:99], v[80:83]
    v_mfma_f32_16x16x32_bf16 v[84:87], a[80:83], a[100:103], v[84:87]
    v_mfma_f32_16x16x32_bf16 v[88:91], a[80:83], a[104:107], v[88:91]
    v_mfma_f32_16x16x32_bf16 v[92:95], a[80:83], a[108:111], v[92:95]
    v_mfma_f32_16x16x32_bf16 v[84:87], a[84:87], a[96:99], v[84:87]
    v_mfma_f32_16x16x32_bf16 v[88:91], a[84:87], a[100:103], v[88:91]
    v_mfma_f32_16x16x32_bf16 v[92:95], a[84:87], a[104:107], v[92:95]
    v_mfma_f32_16x16x32_bf16 v[88:91], a[88:91], a[96:99], v[88:91]
    v_mfma_f32_16x16x32_bf16 v[92:95], a[88:91], a[100:103], v[92:95]
    v_mfma_f32_16x16x32_bf16 v[92:95], a[92:95], a[96:99], v[92:95]
    s_waitcnt lgkmcnt(0)
    v_mfma_f32_16x16x32_bf16 v[64:67], a[0:3], a[32:35], v[64:67]
    ds_read2_b32 a[64:65], v24 offset0:48 offset1:49
    v_mfma_f32_16x16x32_bf16 v[68:71], a[0:3], a[36:39], v[68:71]
    ds_read2_b32 a[66:67], v24 offset0:50 offset1:51
    v_mfma_f32_16x16x32_bf16 v[72:75], a[0:3], a[40:43], v[72:75]
    ds_read_b128 a[96:99], v28 offset:3776
    v_mfma_f32_16x16x32_bf16 v[76:79], a[0:3], a[44:47], v[76:79]
    ds_read_b128 a[100:103], v28 offset:3264
    v_mfma_f32_16x16x32_bf16 v[80:83], a[0:3], a[48:51], v[80:83]
    ds_read_b128 a[104:107], v28 offset:2752
    v_mfma_f32_16x16x32_bf16 v[84:87], a[0:3], a[52:55], v[84:87]
    ds_read_b128 a[108:111], v28 offset:2240
    v_mfma_f32_16x16x32_bf16 v[88:91], a[0:3], a[56:59], v[88:91]
    ds_read_b128 a[112:115], v28 offset:1728
    v_mfma_f32_16x16x32_bf16 v[92:95], a[0:3], a[60:63], v[92:95]
    ds_read_b128 a[116:119], v28 offset:1216
    v_mfma_f32_16x16x32_bf16 v[68:71], a[4:7], a[32:35], v[68:71]
    ds_read_b128 a[120:123], v28 offset:704
    v_mfma_f32_16x16x32_bf16 v[72:75], a[4:7], a[36:39], v[72:75]
    ds_read_b128 a[124:127], v28 offset:192
    v_mfma_f32_16x16x32_bf16 v[76:79], a[4:7], a[40:43], v[76:79]
    ds_read2_b32 a[68:69], v24 offset0:176 offset1:177
    v_mfma_f32_16x16x32_bf16 v[80:83], a[4:7], a[44:47], v[80:83]
    ds_read2_b32 a[70:71], v24 offset0:178 offset1:179
    v_mfma_f32_16x16x32_bf16 v[84:87], a[4:7], a[48:51], v[84:87]
    ds_read2_b32 a[72:73], v25 offset0:48 offset1:49
    v_mfma_f32_16x16x32_bf16 v[88:91], a[4:7], a[52:55], v[88:91]
    ds_read2_b32 a[74:75], v25 offset0:50 offset1:51
    v_mfma_f32_16x16x32_bf16 v[92:95], a[4:7], a[56:59], v[92:95]
    ds_read2_b32 a[76:77], v25 offset0:176 offset1:177
    v_mfma_f32_16x16x32_bf16 v[72:75], a[8:11], a[32:35], v[72:75]
    ds_read2_b32 a[78:79], v25 offset0:178 offset1:179
    v_mfma_f32_16x16x32_bf16 v[76:79], a[8:11], a[36:39], v[76:79]
    ds_read2_b32 a[80:81], v26 offset0:48 offset1:49
    v_mfma_f32_16x16x32_bf16 v[80:83], a[8:11], a[40:43], v[80:83]
    ds_read2_b32 a[82:83], v26 offset0:50 offset1:51
    v_mfma_f32_16x16x32_bf16 v[84:87], a[8:11], a[44:47], v[84:87]
    ds_read2_b32 a[84:85], v26 offset0:176 offset1:177
    v_mfma_f32_16x16x32_bf16 v[88:91], a[8:11], a[48:51], v[88:91]
    ds_read2_b32 a[86:87], v26 offset0:178 offset1:179
    v_mfma_f32_16x16x32_bf16 v[92:95], a[8:11], a[52:55], v[92:95]
    ds_read2_b32 a[88:89], v27 offset0:48 offset1:49
    v_mfma_f32_16x16x32_bf16 v[76:79], a[12:15], a[32:35], v[76:79]
    ds_read2_b32 a[90:91], v27 offset0:50 offset1:51
    v_mfma_f32_16x16x32_bf16 v[80:83], a[12:15], a[36:39], v[80:83]
    ds_read2_b32 a[92:93], v27 offset0:176 offset1:177
    v_mfma_f32_16x16x32_bf16 v[84:87], a[12:15], a[40:43], v[84:87]
    ds_read2_b32 a[94:95], v27 offset0:178 offset1:179
    v_mfma_f32_16x16x32_bf16 v[88:91], a[12:15], a[44:47], v[88:91]
    v_mfma_f32_16x16x32_bf16 v[92:95], a[12:15], a[48:51], v[92:95]
    v_mfma_f32_16x16x32_bf16 v[80:83], a[16:19], a[32:35], v[80:83]
    v_mfma_f32_16x16x32_bf16 v[84:87], a[16:19], a[36:39], v[84:87]
    v_mfma_f32_16x16x32_bf16 v[88:91], a[16:19], a[40:43], v[88:91]
    v_mfma_f32_16x16x32_bf16 v[92:95], a[16:19], a[44:47], v[92:95]
    v_mfma_f32_16x16x32_bf16 v[84:87], a[20:23], a[32:35], v[84:87]
    v_mfma_f32_16x16x32_bf16 v[88:91], a[20:23], a[36:39], v[88:91]
    v_mfma_f32_16x16x32_bf16 v[92:95], a[20:23], a[40:43], v[92:95]
    v_mfma_f32_16x16x32_bf16 v[88:91], a[24:27], a[32:35], v[88:91]
    v_mfma_f32_16x16x32_bf16 v[92:95], a[24:27], a[36:39], v[92:95]
    v_mfma_f32_16x16x32_bf16 v[92:95], a[28:31], a[32:35], v[92:95]
    s_waitcnt lgkmcnt(0)
    v_mfma_f32_16x16x32_bf16 v[64:67], a[64:67], a[96:99], v[64:67]
    v_mfma_f32_16x16x32_bf16 v[68:71], a[64:67], a[100:103], v[68:71]
    v_mfma_f32_16x16x32_bf16 v[72:75], a[64:67], a[104:107], v[72:75]
    v_mfma_f32_16x16x32_bf16 v[76:79], a[64:67], a[108:111], v[76:79]
    v_mfma_f32_16x16x32_bf16 v[80:83], a[64:67], a[112:115], v[80:83]
    v_mfma_f32_16x16x32_bf16 v[84:87], a[64:67], a[116:119], v[84:87]
    v_mfma_f32_16x16x32_bf16 v[88:91], a[64:67], a[120:123], v[88:91]
    v_mfma_f32_16x16x32_bf16 v[92:95], a[64:67], a[124:127], v[92:95]
    v_mfma_f32_16x16x32_bf16 v[68:71], a[68:71], a[96:99], v[68:71]
    v_mfma_f32_16x16x32_bf16 v[72:75], a[68:71], a[100:103], v[72:75]
    v_mfma_f32_16x16x32_bf16 v[76:79], a[68:71], a[104:107], v[76:79]
    v_mfma_f32_16x16x32_bf16 v[80:83], a[68:71], a[108:111], v[80:83]
    v_mfma_f32_16x16x32_bf16 v[84:87], a[68:71], a[112:115], v[84:87]
    v_mfma_f32_16x16x32_bf16 v[88:91], a[68:71], a[116:119], v[88:91]
    v_mfma_f32_16x16x32_bf16 v[92:95], a[68:71], a[120:123], v[92:95]
    v_mfma_f32_16x16x32_bf16 v[72:75], a[72:75], a[96:99], v[72:75]
    v_mfma_f32_16x16x32_bf16 v[76:79], a[72:75], a[100:103], v[76:79]
    v_mfma_f32_16x16x32_bf16 v[80:83], a[72:75], a[104:107], v[80:83]
    v_mfma_f32_16x16x32_bf16 v[84:87], a[72:75], a[108:111], v[84:87]
    v_mfma_f32_16x16x32_bf16 v[88:91], a[72:75], a[112:115], v[88:91]
    v_mfma_f32_16x16x32_bf16 v[92:95], a[72:75], a[116:119], v[92:95]
    v_mfma_f32_16x16x32_bf16 v[76:79], a[76:79], a[96:99], v[76:79]
    v_mfma_f32_16x16x32_bf16 v[80:83], a[76:79], a[100:103], v[80:83]
    v_mfma_f32_16x16x32_bf16 v[84:87], a[76:79], a[104:107], v[84:87]
    v_mfma_f32_16x16x32_bf16 v[88:91], a[76:79], a[108:111], v[88:91]
    v_mfma_f32_16x16x32_bf16 v[92:95], a[76:79], a[112:115], v[92:95]
    v_mfma_f32_16x16x32_bf16 v[80:83], a[80:83], a[96:99], v[80:83]
    v_mfma_f32_16x16x32_bf16 v[84:87], a[80:83], a[100:103], v[84:87]
    v_mfma_f32_16x16x32_bf16 v[88:91], a[80:83], a[104:107], v[88:91]
    v_mfma_f32_16x16x32_bf16 v[92:95], a[80:83], a[108:111], v[92:95]
    v_mfma_f32_16x16x32_bf16 v[84:87], a[84:87], a[96:99], v[84:87]
    v_mfma_f32_16x16x32_bf16 v[88:91], a[84:87], a[100:103], v[88:91]
    v_mfma_f32_16x16x32_bf16 v[92:95], a[84:87], a[104:107], v[92:95]
    v_mfma_f32_16x16x32_bf16 v[88:91], a[88:91], a[96:99], v[88:91]
    v_mfma_f32_16x16x32_bf16 v[92:95], a[88:91], a[100:103], v[92:95]
    v_mfma_f32_16x16x32_bf16 v[92:95], a[92:95], a[96:99], v[92:95]
    s_nop 6
    s_cmp_eq_u32 s7, 0
    s_cbranch_scc0 C_SEND1
    ds_write_b128 v29, v[80:83] offset:0
    ds_write_b128 v29, v[84:87] offset:1024
    ds_write_b128 v29, v[88:91] offset:2048
    ds_write_b128 v29, v[92:95] offset:3072
    s_branch C_SENT
C_SEND1:
    ds_write_b128 v29, v[64:67] offset:0
    ds_write_b128 v29, v[68:71] offset:1024
    ds_write_b128 v29, v[72:75] offset:2048
    ds_write_b128 v29, v[76:79] offset:3072
    v_pk_mul_f32 v[64:65], v[80:81], 1.0 op_sel_hi:[1,0]
    v_pk_mul_f32 v[66:67], v[82:83], 1.0 op_sel_hi:[1,0]
    v_pk_mul_f32 v[68:69], v[84:85], 1.0 op_sel_hi:[1,0]
    v_pk_mul_f32 v[70:71], v[86:87], 1.0 op_sel_hi:[1,0]
    v_pk_mul_f32 v[72:73], v[88:89], 1.0 op_sel_hi:[1,0]
    v_pk_mul_f32 v[74:75], v[90:91], 1.0 op_sel_hi:[1,0]
    v_pk_mul_f32 v[76:77], v[92:93], 1.0 op_sel_hi:[1,0]
    v_pk_mul_f32 v[78:79], v[94:95], 1.0 op_sel_hi:[1,0]
C_SENT:
    ds_read_b64 v[32:33], v9 offset:1536
    ds_read_b64 v[34:35], v9 offset:1024
    ds_read_b64 v[36:37], v9 offset:512
    ds_read_b64 v[38:39], v9 offset:0
    v_mov_b32 v13, v30
    s_mov_b64 exec, 1
    ds_add_u32 v14, v15
    s_mov_b64 exec, -1
    s_mov_b32 s77, 262144
SPIN_8:
    ds_read_b32 v15, v14
    s_waitcnt lgkmcnt(0)
    v_readfirstlane_b32 s75, v15
    s_cmp_ge_u32 s75, 6
    s_cbranch_scc1 SPINOK_9
    s_sub_u32 s77, s77, 1
    s_cbranch_scc0 SPIN_8
SPINOK_9:
    ds_read_b64 v[40:41], v8 offset:0
    ds_read_b64 v[42:43], v8 offset:512
    ds_read_b64 v[44:45], v8 offset:1024
    ds_read_b64 v[46:47], v8 offset:1536
    ds_read_b128 v[96:99], v10 offset:0
    ds_read_b128 v[112:115], v10 offset:32
    ds_read_b128 v[100:103], v10 offset:2048
    ds_read_b128 v[116:119], v10 offset:2080
    ds_read_b128 v[104:107], v10 offset:4096
    ds_read_b128 v[120:123], v10 offset:4128
    ds_read_b128 v[108:111], v10 offset:6144
    ds_read_b128 v[124:127], v10 offset:6176
    ds_read_b128 v[16:19], v13 offset:0
    ds_read_b128 v[20:23], v13 offset:1024
    ds_read_b128 v[24:27], v13 offset:2048
    ds_read_b128 v[28:31], v13 offset:3072
    v_and_b32 v48, s76, v33
    v_lshlrev_b32 v49, 16, v33
    v_and_b32 v50, s76, v32
    v_lshlrev_b32 v51, 16, v32
    v_pk_fma_f32 v[64:65], v[48:49], s[70:71], v[64:65]
    v_pk_fma_f32 v[66:67], v[50:51], s[70:71], v[66:67]
    v_and_b32 v52, s76, v35
    v_lshlrev_b32 v53, 16, v35
    v_and_b32 v54, s76, v34
    v_lshlrev_b32 v55, 16, v34
    v_pk_fma_f32 v[68:69], v[52:53], s[70:71], v[68:69]
    v_pk_fma_f32 v[70:71], v[54:55], s[70:71], v[70:71]
    v_and_b32 v48, s76, v37
    v_lshlrev_b32 v49, 16, v37
    v_and_b32 v50, s76, v36
    v_lshlrev_b32 v51, 16, v36
    v_pk_fma_f32 v[72:73], v[48:49], s[70:71], v[72:73]
    v_pk_fma_f32 v[74:75], v[50:51], s[70:71], v[74:75]
    v_and_b32 v52, s76, v39
    v_lshlrev_b32 v53, 16, v39
    v_and_b32 v54, s76, v38
    v_lshlrev_b32 v55, 16, v38
    v_pk_fma_f32 v[76:77], v[52:53], s[70:71], v[76:77]
    v_pk_fma_f32 v[78:79], v[54:55], s[70:71], v[78:79]
    s_waitcnt lgkmcnt(12)
    v_lshlrev_b32 v80, 16, v40
    v_and_b32 v81, s76, v40
    v_lshlrev_b32 v82, 16, v41
    v_and_b32 v83, s76, v41
    v_lshlrev_b32 v84, 16, v42
    v_and_b32 v85, s76, v42
    v_lshlrev_b32 v86, 16, v43
    v_and_b32 v87, s76, v43
    v_lshlrev_b32 v88, 16, v44
    v_and_b32 v89, s76, v44
    v_lshlrev_b32 v90, 16, v45
    v_and_b32 v91, s76, v45
    v_lshlrev_b32 v92, 16, v46
    v_and_b32 v93, s76, v46
    v_lshlrev_b32 v94, 16, v47
    v_and_b32 v95, s76, v47
    s_waitcnt lgkmcnt(4)
    v_pk_fma_f32 v[96:97], v[80:81], v[96:97], v[112:113]
    v_pk_fma_f32 v[98:99], v[82:83], v[98:99], v[114:115]
    v_pk_fma_f32 v[100:101], v[84:85], v[100:101], v[116:117]
    v_pk_fma_f32 v[102:103], v[86:87], v[102:103], v[118:119]
    v_pk_fma_f32 v[104:105], v[88:89], v[104:105], v[120:121]
    v_pk_fma_f32 v[106:107], v[90:91], v[106:107], v[122:123]
    v_pk_fma_f32 v[108:109], v[92:93], v[108:109], v[124:125]
    v_pk_fma_f32 v[110:111], v[94:95], v[110:111], v[126:127]
    s_waitcnt lgkmcnt(0)
    v_pk_add_f32 v[64:65], v[64:65], v[16:17]
    v_pk_add_f32 v[66:67], v[66:67], v[18:19]
    v_pk_add_f32 v[68:69], v[68:69], v[20:21]
    v_pk_add_f32 v[70:71], v[70:71], v[22:23]
    v_pk_add_f32 v[72:73], v[72:73], v[24:25]
    v_pk_add_f32 v[74:75], v[74:75], v[26:27]
    v_pk_add_f32 v[76:77], v[76:77], v[28:29]
    v_pk_add_f32 v[78:79], v[78:79], v[30:31]
    v_pk_fma_f32 v[96:97], v[96:97], v[64:65], v[80:81]
    v_pk_fma_f32 v[98:99], v[98:99], v[66:67], v[82:83]
    v_pk_fma_f32 v[100:101], v[100:101], v[68:69], v[84:85]
    v_pk_fma_f32 v[102:103], v[102:103], v[70:71], v[86:87]
    v_cvt_pk_bf16_f32 v56, v96, v97
    v_cvt_pk_bf16_f32 v57, v98, v99
    v_cvt_pk_bf16_f32 v58, v100, v101
    v_cvt_pk_bf16_f32 v59, v102, v103
    s_nop 1
    v_permlane16_swap_b32 v56, v58
    v_permlane16_swap_b32 v57, v59
    buffer_store_dwordx4 v[56:59], v11, s[56:59], 0 offen offset:0 sc1
    v_pk_fma_f32 v[104:105], v[104:105], v[72:73], v[88:89]
    v_pk_fma_f32 v[106:107], v[106:107], v[74:75], v[90:91]
    v_pk_fma_f32 v[108:109], v[108:109], v[76:77], v[92:93]
    v_pk_fma_f32 v[110:111], v[110:111], v[78:79], v[94:95]
    v_cvt_pk_bf16_f32 v60, v104, v105
    v_cvt_pk_bf16_f32 v61, v106, v107
    v_cvt_pk_bf16_f32 v62, v108, v109
    v_cvt_pk_bf16_f32 v63, v110, v111
    s_nop 1
    v_permlane16_swap_b32 v60, v62
    v_permlane16_swap_b32 v61, v63
    buffer_store_dwordx4 v[60:63], v11, s[56:59], 0 offen offset:1024 sc1
    s_lshl_b32 s4, s74, 3
    s_add_u32 s4, s4, s60
    s_mul_i32 s5, s4, 28672
    s_add_u32 s5, s5, 5652480
    v_lshl_add_u32 v86, v1, 4, s5
    s_lshl_b32 s4, s4, 6
    v_and_b32 v14, 31, v1
    v_lshl_add_u32 v14, v14, 1, s4
    v_lshrrev_b32 v3, 5, v1
    v_mul_u32_u24 v12, 28672, v3
    v_lshl_add_u32 v12, v14, 1, v12
    v_add_u32 v12, 5586944, v12
    s_mul_i32 s4, s74, 112
    s_mul_i32 s5, s61, 14
    s_add_u32 s4, s4, s5
    s_lshl_b32 s4, s4, 11
    s_add_u32 s4, s4, 7258112
    v_lshl_add_u32 v6, v1, 4, s4
    s_waitcnt vmcnt(0)
    v_mov_b32 v2, 139276
    v_mov_b32 v3, 1
    s_mov_b64 exec, 1
    ds_add_rtn_u32 v3, v2, v3
    s_waitcnt lgkmcnt(0)
    s_mov_b64 exec, -1
    v_readfirstlane_b32 s75, v3
    s_cmp_lg_u32 s75, 3
    s_cbranch_scc1 C_S2_DONE
    s_mov_b32 s75, 1
    s_atomic_add s75, s[56:57], s6 glc
    s_waitcnt lgkmcnt(0)
    s_cmp_lg_u32 s75, 27
    s_cbranch_scc1 ARR_10
    s_mov_b32 s75, 1
    s_atomic_add s75, s[56:57], 12288
    s_atomic_add s75, s[56:57], 12544
    s_atomic_add s75, s[56:57], 12800
    s_atomic_add s75, s[56:57], 13056
    s_atomic_add s75, s[56:57], 13312
    s_atomic_add s75, s[56:57], 13568
    s_atomic_add s75, s[56:57], 13824
    s_atomic_add s75, s[56:57], 14080
    s_waitcnt lgkmcnt(0)
ARR_10:
C_S2_DONE:
    buffer_load_ushort v7, v14, s[36:39], 0 offen
    buffer_load_dword v8, v12, s[56:59], 0 offen sc1
    s_movk_i32 s6, 7168
    buffer_load_dword v9, v12, s[56:59], s6 offen sc1
    s_movk_i32 s6, 14336
    buffer_load_dword v10, v12, s[56:59], s6 offen sc1
    s_movk_i32 s6, 21504
    buffer_load_dword v11, v12, s[56:59], s6 offen sc1
    s_mov_b32 s6, 0
    buffer_load_dwordx4 a[0:3], v86, s[56:59], s6 offen offset:0 sc1
    buffer_load_dwordx4 a[4:7], v86, s[56:59], s6 offen offset:1024 sc1
    buffer_load_dwordx4 a[8:11], v86, s[56:59], s6 offen offset:2048 sc1
    buffer_load_dwordx4 a[12:15], v86, s[56:59], s6 offen offset:3072 sc1
    s_mov_b32 s6, 4096
    buffer_load_dwordx4 a[16:19], v86, s[56:59], s6 offen offset:0 sc1
    buffer_load_dwordx4 a[20:23], v86, s[56:59], s6 offen offset:1024 sc1
    buffer_load_dwordx4 a[24:27], v86, s[56:59], s6 offen offset:2048 sc1
    buffer_load_dwordx4 a[28:31], v86, s[56:59], s6 offen offset:3072 sc1
    s_mov_b32 s6, 8192
    buffer_load_dwordx4 a[32:35], v86, s[56:59], s6 offen offset:0 sc1
    buffer_load_dwordx4 a[36:39], v86, s[56:59], s6 offen offset:1024 sc1
    buffer_load_dwordx4 a[40:43], v86, s[56:59], s6 offen offset:2048 sc1
    buffer_load_dwordx4 a[44:47], v86, s[56:59], s6 offen offset:3072 sc1
    s_mov_b32 s6, 12288
    buffer_load_dwordx4 a[48:51], v86, s[56:59], s6 offen offset:0 sc1
    buffer_load_dwordx4 a[52:55], v86, s[56:59], s6 offen offset:1024 sc1
    buffer_load_dwordx4 a[56:59], v86, s[56:59], s6 offen offset:2048 sc1
    buffer_load_dwordx4 a[60:63], v86, s[56:59], s6 offen offset:3072 sc1
    s_mov_b32 s6, 16384
    buffer_load_dwordx4 a[64:67], v86, s[56:59], s6 offen offset:0 sc1
    buffer_load_dwordx4 a[68:71], v86, s[56:59], s6 offen offset:1024 sc1
    buffer_load_dwordx4 a[72:75], v86, s[56:59], s6 offen offset:2048 sc1
    buffer_load_dwordx4 a[76:79], v86, s[56:59], s6 offen offset:3072 sc1
    v_lshrrev_b32 v2, 5, v1
    v_bfe_u32 v3, v1, 2, 2
    v_lshl_add_u32 v2, v2, 3, v3
    v_lshlrev_b32 v2, 7, v2
    v_lshrrev_b32 v3, 1, v3
    v_lshl_add_u32 v2, v3, 6, v2
    v_bfe_u32 v3, v1, 4, 1
    v_lshl_add_u32 v2, v3, 5, v2
    v_and_b32 v3, 3, v1
    v_lshl_add_u32 v2, v3, 3, v2
    v_add_u32 v2, 65536, v2
    v_xor_b32 v3, 64, v2
    s_mul_i32 s4, s73, 112
    s_lshl_b32 s5, s74, 4
    s_add_u32 s4, s4, s5
    s_lshl_b32 s5, s60, 1
    s_add_u32 s4, s4, s5
    s_lshl_b32 s4, s4, 11
    s_add_u32 s4, s4, 8863744
    v_lshl_add_u32 v4, v1, 4, s4
    v_mov_b32 v74, 0x3f803f80
    v_mov_b32 v75, 0x3f803f80
    s_lshl_b32 s4, s3, 11
    v_add_u32 v76, s4, v2
    v_add_u32 v77, s4, v3
    s_waitcnt vmcnt(20)
    v_cmp_gt_u32 vcc, 32, v1
    v_add_f32 v8, v8, v9
    v_add_f32 v10, v10, v11
    v_add_f32 v8, v8, v10
    v_mov_b32 v9, v8
    s_nop 1
    v_permlane32_swap_b32 v8, v9
    v_add_f32 v8, v8, v9
    v_cvt_pk_bf16_f32 v9, v8, v8
    v_lshlrev_b32 v9, 16, v9
    v_sub_f32 v9, v8, v9
    v_cvt_pk_bf16_f32 v56, v8, v9
    v_and_b32 v57, 0xffff, v56
    v_lshl_or_b32 v57, v7, 16, v57
    v_mov_b32 v59, 0
    v_mov_b32 v63, 0
    v_cndmask_b32 v56, 0, v56, vcc
    v_cndmask_b32 v57, 0, v57, vcc
    v_cndmask_b32 v58, 0, v7, vcc
    v_mov_b32 v67, 0
    s_barrier
    s_barrier
    ds_read_b64_tr_b16 v[24:25], v76 offset:0
    ds_read_b64_tr_b16 v[26:27], v76 offset:512
    ds_read_b64_tr_b16 v[28:29], v77 offset:0
    ds_read_b64_tr_b16 v[30:31], v77 offset:512
    s_barrier
    ds_read_b64_tr_b16 v[32:33], v76 offset:8192
    ds_read_b64_tr_b16 v[34:35], v76 offset:8704
    ds_read_b64_tr_b16 v[36:37], v77 offset:8192
    ds_read_b64_tr_b16 v[38:39], v77 offset:8704
    s_waitcnt lgkmcnt(4)
    v_mfma_f32_4x4x4_16b_bf16 v[8:11], v[24:25], v[24:25], 0
    v_mfma_f32_4x4x4_16b_bf16 v[12:15], v[74:75], v[24:25], 0
    v_mfma_f32_4x4x4_16b_bf16 v[16:19], v[28:29], v[28:29], 0
    v_mfma_f32_4x4x4_16b_bf16 v[20:23], v[74:75], v[28:29], 0
    v_mfma_f32_4x4x4_16b_bf16 v[8:11], v[26:27], v[26:27], v[8:11]
    v_mfma_f32_4x4x4_16b_bf16 v[12:15], v[74:75], v[26:27], v[12:15]
    v_mfma_f32_4x4x4_16b_bf16 v[16:19], v[30:31], v[30:31], v[16:19]
    v_mfma_f32_4x4x4_16b_bf16 v[20:23], v[74:75], v[30:31], v[20:23]
    s_barrier
    ds_read_b64_tr_b16 v[24:25], v76 offset:16384
    ds_read_b64_tr_b16 v[26:27], v76 offset:16896
    ds_read_b64_tr_b16 v[28:29], v77 offset:16384
    ds_read_b64_tr_b16 v[30:31], v77 offset:16896
    s_waitcnt lgkmcnt(4)
    v_mfma_f32_4x4x4_16b_bf16 v[8:11], v[32:33], v[32:33], v[8:11]
    v_mfma_f32_4x4x4_16b_bf16 v[12:15], v[74:75], v[32:33], v[12:15]
    v_mfma_f32_4x4x4_16b_bf16 v[16:19], v[36:37], v[36:37], v[16:19]
    v_mfma_f32_4x4x4_16b_bf16 v[20:23], v[74:75], v[36:37], v[20:23]
    v_mfma_f32_4x4x4_16b_bf16 v[8:11], v[34:35], v[34:35], v[8:11]
    v_mfma_f32_4x4x4_16b_bf16 v[12:15], v[74:75], v[34:35], v[12:15]
    v_mfma_f32_4x4x4_16b_bf16 v[16:19], v[38:39], v[38:39], v[16:19]
    v_mfma_f32_4x4x4_16b_bf16 v[20:23], v[74:75], v[38:39], v[20:23]
    s_mov_b32 s6, 20480
    buffer_load_dwordx4 a[80:83], v86, s[56:59], s6 offen offset:0 sc1
    buffer_load_dwordx4 a[84:87], v86, s[56:59], s6 offen offset:1024 sc1
    s_barrier
    ds_read_b64_tr_b16 v[32:33], v76 offset:24576
    ds_read_b64_tr_b16 v[34:35], v76 offset:25088
    ds_read_b64_tr_b16 v[36:37], v77 offset:24576
    ds_read_b64_tr_b16 v[38:39], v77 offset:25088
    s_waitcnt lgkmcnt(4)
    v_mfma_f32_4x4x4_16b_bf16 v[8:11], v[24:25], v[24:25], v[8:11]
    v_mfma_f32_4x4x4_16b_bf16 v[12:15], v[74:75], v[24:25], v[12:15]
    v_mfma_f32_4x4x4_16b_bf16 v[16:19], v[28:29], v[28:29], v[16:19]
    v_mfma_f32_4x4x4_16b_bf16 v[20:23], v[74:75], v[28:29], v[20:23]
    v_mfma_f32_4x4x4_16b_bf16 v[8:11], v[26:27], v[26:27], v[8:11]
    v_mfma_f32_4x4x4_16b_bf16 v[12:15], v[74:75], v[26:27], v[12:15]
    v_mfma_f32_4x4x4_16b_bf16 v[16:19], v[30:31], v[30:31], v[16:19]
    v_mfma_f32_4x4x4_16b_bf16 v[20:23], v[74:75], v[30:31], v[20:23]
    buffer_load_dwordx4 a[88:91], v86, s[56:59], s6 offen offset:2048 sc1
    buffer_load_dwordx4 a[92:95], v86, s[56:59], s6 offen offset:3072 sc1
    s_barrier
    ds_read_b64_tr_b16 v[24:25], v76 offset:32768
    ds_read_b64_tr_b16 v[26:27], v76 offset:33280
    ds_read_b64_tr_b16 v[28:29], v77 offset:32768
    ds_read_b64_tr_b16 v[30:31], v77 offset:33280
    s_waitcnt lgkmcnt(4)
    v_mfma_f32_4x4x4_16b_bf16 v[8:11], v[32:33], v[32:33], v[8:11]
    v_mfma_f32_4x4x4_16b_bf16 v[12:15], v[74:75], v[32:33], v[12:15]
    v_mfma_f32_4x4x4_16b_bf16 v[16:19], v[36:37], v[36:37], v[16:19]
    v_mfma_f32_4x4x4_16b_bf16 v[20:23], v[74:75], v[36:37], v[20:23]
    v_mfma_f32_4x4x4_16b_bf16 v[8:11], v[34:35], v[34:35], v[8:11]
    v_mfma_f32_4x4x4_16b_bf16 v[12:15], v[74:75], v[34:35], v[12:15]
    v_mfma_f32_4x4x4_16b_bf16 v[16:19], v[38:39], v[38:39], v[16:19]
    v_mfma_f32_4x4x4_16b_bf16 v[20:23], v[74:75], v[38:39], v[20:23]
    s_mov_b32 s6, 24576
    buffer_load_dwordx4 a[96:99], v86, s[56:59], s6 offen offset:0 sc1
    buffer_load_dwordx4 a[100:103], v86, s[56:59], s6 offen offset:1024 sc1
    s_barrier
    ds_read_b64_tr_b16 v[32:33], v76 offset:40960
    ds_read_b64_tr_b16 v[34:35], v76 offset:41472
    ds_read_b64_tr_b16 v[36:37], v77 offset:40960
    ds_read_b64_tr_b16 v[38:39], v77 offset:41472
    s_waitcnt lgkmcnt(4)
    v_mfma_f32_4x4x4_16b_bf16 v[8:11], v[24:25], v[24:25], v[8:11]
    v_mfma_f32_4x4x4_16b_bf16 v[12:15], v[74:75], v[24:25], v[12:15]
    v_mfma_f32_4x4x4_16b_bf16 v[16:19], v[28:29], v[28:29], v[16:19]
    v_mfma_f32_4x4x4_16b_bf16 v[20:23], v[74:75], v[28:29], v[20:23]
    v_mfma_f32_4x4x4_16b_bf16 v[8:11], v[26:27], v[26:27], v[8:11]
    v_mfma_f32_4x4x4_16b_bf16 v[12:15], v[74:75], v[26:27], v[12:15]
    v_mfma_f32_4x4x4_16b_bf16 v[16:19], v[30:31], v[30:31], v[16:19]
    v_mfma_f32_4x4x4_16b_bf16 v[20:23], v[74:75], v[30:31], v[20:23]
    buffer_load_dwordx4 a[104:107], v86, s[56:59], s6 offen offset:2048 sc1
    s_barrier
    ds_read_b64_tr_b16 v[24:25], v76 offset:49152
    ds_read_b64_tr_b16 v[26:27], v76 offset:49664
    ds_read_b64_tr_b16 v[28:29], v77 offset:49152
    ds_read_b64_tr_b16 v[30:31], v77 offset:49664
    s_waitcnt lgkmcnt(4)
    v_mfma_f32_4x4x4_16b_bf16 v[8:11], v[32:33], v[32:33], v[8:11]
    v_mfma_f32_4x4x4_16b_bf16 v[12:15], v[74:75], v[32:33], v[12:15]
    v_mfma_f32_4x4x4_16b_bf16 v[16:19], v[36:37], v[36:37], v[16:19]
    v_mfma_f32_4x4x4_16b_bf16 v[20:23], v[74:75], v[36:37], v[20:23]
    v_mfma_f32_4x4x4_16b_bf16 v[8:11], v[34:35], v[34:35], v[8:11]
    v_mfma_f32_4x4x4_16b_bf16 v[12:15], v[74:75], v[34:35], v[12:15]
    v_mfma_f32_4x4x4_16b_bf16 v[16:19], v[38:39], v[38:39], v[16:19]
    v_mfma_f32_4x4x4_16b_bf16 v[20:23], v[74:75], v[38:39], v[20:23]
    buffer_load_dwordx4 a[108:111], v86, s[56:59], s6 offen offset:3072 sc1
    v_and_b32 v78, 3, v1
    v_cmp_eq_u32 vcc, 1, v78
    v_cmp_eq_u32 s[4:5], 2, v78
    v_cmp_eq_u32 s[6:7], 3, v78
    s_waitcnt lgkmcnt(0)
    v_mfma_f32_4x4x4_16b_bf16 v[8:11], v[24:25], v[24:25], v[8:11]
    v_mfma_f32_4x4x4_16b_bf16 v[12:15], v[74:75], v[24:25], v[12:15]
    v_mfma_f32_4x4x4_16b_bf16 v[16:19], v[28:29], v[28:29], v[16:19]
    v_mfma_f32_4x4x4_16b_bf16 v[20:23], v[74:75], v[28:29], v[20:23]
    v_mfma_f32_4x4x4_16b_bf16 v[8:11], v[26:27], v[26:27], v[8:11]
    v_mfma_f32_4x4x4_16b_bf16 v[12:15], v[74:75], v[26:27], v[12:15]
    v_mfma_f32_4x4x4_16b_bf16 v[16:19], v[30:31], v[30:31], v[16:19]
    v_mfma_f32_4x4x4_16b_bf16 v[20:23], v[74:75], v[30:31], v[20:23]
    s_lshl_b32 s75, s3, 9
    s_add_u32 s75, s75, 139328
    v_lshl_add_u32 v79, v1, 3, s75
    s_nop 2
    v_cndmask_b32 v8, v8, v9, vcc
    v_cndmask_b32 v8, v8, v10, s[4:5]
    v_cndmask_b32 v8, v8, v11, s[6:7]
    v_cndmask_b32 v16, v16, v17, vcc
    v_cndmask_b32 v16, v16, v18, s[4:5]
    v_cndmask_b32 v16, v16, v19, s[6:7]
    s_nop 1
    v_permlane32_swap_b32 v8, v16
    v_permlane32_swap_b32 v12, v20
    v_add_f32 v81, v8, v16
    v_add_f32 v80, v12, v20
    ds_write_b64 v79, v[80:81]
    s_waitcnt lgkmcnt(0)
    s_barrier
    v_lshlrev_b32 v76, 3, v1
    v_add_u32 v76, 139328, v76
    ds_read_b64 v[78:79], v76 offset:0
    ds_read_b64 v[80:81], v76 offset:512
    ds_read_b64 v[82:83], v76 offset:1024
    ds_read_b64 v[84:85], v76 offset:1536
    s_setprio 2
    ds_read_b64_tr_b16 v[24:25], v2 offset:0
    ds_read_b64_tr_b16 v[26:27], v2 offset:512
    ds_read_b64_tr_b16 v[28:29], v2 offset:2048
    ds_read_b64_tr_b16 v[30:31], v2 offset:2560
    ds_read_b64_tr_b16 v[32:33], v2 offset:4096
    ds_read_b64_tr_b16 v[34:35], v2 offset:4608
    ds_read_b64_tr_b16 v[36:37], v2 offset:6144
    ds_read_b64_tr_b16 v[38:39], v2 offset:6656
    ds_read_b64_tr_b16 v[40:41], v2 offset:8192
    ds_read_b64_tr_b16 v[42:43], v2 offset:8704
    s_waitcnt lgkmcnt(8)
    s_waitcnt vmcnt(8)
    v_mfma_f32_32x32x16_bf16 v[8:23], a[0:3], v[24:27], 0
    ds_read_b64_tr_b16 v[44:45], v2 offset:10240
    ds_read_b64_tr_b16 v[46:47], v2 offset:10752
    s_waitcnt lgkmcnt(8)
    v_mfma_f32_32x32x16_bf16 v[8:23], a[4:7], v[28:31], v[8:23]
    ds_read_b64_tr_b16 v[48:49], v2 offset:12288
    ds_read_b64_tr_b16 v[50:51], v2 offset:12800
    s_waitcnt lgkmcnt(8)
    v_mfma_f32_32x32x16_bf16 v[8:23], a[8:11], v[32:35], v[8:23]
    ds_read_b64_tr_b16 v[52:53], v2 offset:14336
    ds_read_b64_tr_b16 v[54:55], v2 offset:14848
    s_waitcnt lgkmcnt(8)
    v_mfma_f32_32x32x16_bf16 v[8:23], a[12:15], v[36:39], v[8:23]
    v_add_f32 v78, v78, v80
    v_add_f32 v79, v79, v81
    ds_read_b64_tr_b16 v[24:25], v2 offset:16384
    ds_read_b64_tr_b16 v[26:27], v2 offset:16896
    s_waitcnt lgkmcnt(8)
    v_mfma_f32_32x32x16_bf16 v[8:23], a[16:19], v[40:43], v[8:23]
    v_add_f32 v82, v82, v84
    v_add_f32 v83, v83, v85
    ds_read_b64_tr_b16 v[28:29], v2 offset:18432
    ds_read_b64_tr_b16 v[30:31], v2 offset:18944
    s_waitcnt lgkmcnt(8)
    v_mfma_f32_32x32x16_bf16 v[8:23], a[20:23], v[44:47], v[8:23]
    v_add_f32 v78, v78, v82
    v_add_f32 v79, v79, v83
    ds_read_b64_tr_b16 v[32:33], v2 offset:20480
    ds_read_b64_tr_b16 v[34:35], v2 offset:20992
    s_waitcnt lgkmcnt(8)
    v_mfma_f32_32x32x16_bf16 v[8:23], a[24:27], v[48:51], v[8:23]
    v_mul_f32 v78, 0xbb124925, v78
    v_mul_f32 v79, 0x3b124925, v79
    ds_read_b64_tr_b16 v[36:37], v2 offset:22528
    ds_read_b64_tr_b16 v[38:39], v2 offset:23040
    s_waitcnt lgkmcnt(8)
    v_mfma_f32_32x32x16_bf16 v[8:23], a[28:31], v[52:55], v[8:23]
    v_fma_f32 v79, -v78, v78, v79
    v_max_f32 v79, 0, v79
    ds_read_b64_tr_b16 v[40:41], v2 offset:24576
    ds_read_b64_tr_b16 v[42:43], v2 offset:25088
    s_waitcnt lgkmcnt(8)
    v_mfma_f32_32x32x16_bf16 v[8:23], a[32:35], v[24:27], v[8:23]
    v_add_f32 v80, 0x3727c5ac, v79
    v_rsq_f32 v80, v80
    ds_read_b64_tr_b16 v[44:45], v2 offset:26624
    ds_read_b64_tr_b16 v[46:47], v2 offset:27136
    s_waitcnt lgkmcnt(8)
    v_mfma_f32_32x32x16_bf16 v[8:23], a[36:39], v[28:31], v[8:23]
    v_cvt_pk_bf16_f32 v60, v78, v78
    v_mul_f32 v79, v79, v80
    ds_read_b64_tr_b16 v[48:49], v2 offset:28672
    ds_read_b64_tr_b16 v[50:51], v2 offset:29184
    s_waitcnt lgkmcnt(8)
    v_mfma_f32_32x32x16_bf16 v[8:23], a[40:43], v[32:35], v[8:23]
    v_mul_f32 v79, v79, v80
    v_add_f32 v79, 0x3727c5ac, v79
    ds_read_b64_tr_b16 v[52:53], v2 offset:30720
    ds_read_b64_tr_b16 v[54:55], v2 offset:31232
    s_waitcnt lgkmcnt(8)
    v_mfma_f32_32x32x16_bf16 v[8:23], a[44:47], v[36:39], v[8:23]
    v_rsq_f32 v79, v79
    v_lshlrev_b32 v81, 16, v60
    ds_read_b64_tr_b16 v[24:25], v2 offset:32768
    ds_read_b64_tr_b16 v[26:27], v2 offset:33280
    s_waitcnt lgkmcnt(8)
    v_mfma_f32_32x32x16_bf16 v[8:23], a[48:51], v[40:43], v[8:23]
    v_mul_f32 v79, v79, v80
    v_rcp_f32 v72, v79
    ds_read_b64_tr_b16 v[28:29], v2 offset:34816
    ds_read_b64_tr_b16 v[30:31], v2 offset:35328
    s_waitcnt lgkmcnt(8)
    v_mfma_f32_32x32x16_bf16 v[8:23], a[52:55], v[44:47], v[8:23]
    v_sub_f32 v81, v78, v81
    v_mul_f32 v68, 0xc0135761, v79
    ds_read_b64_tr_b16 v[32:33], v2 offset:36864
    ds_read_b64_tr_b16 v[34:35], v2 offset:37376
    s_waitcnt lgkmcnt(8)
    v_mfma_f32_32x32x16_bf16 v[8:23], a[56:59], v[48:51], v[8:23]
    v_mul_f32 v80, v79, v79
    v_mul_f32 v80, 0x3d372713, v80
    ds_read_b64_tr_b16 v[36:37], v2 offset:38912
    ds_read_b64_tr_b16 v[38:39], v2 offset:39424
    s_waitcnt lgkmcnt(8)
    v_mfma_f32_32x32x16_bf16 v[8:23], a[60:63], v[52:55], v[8:23]
    v_mul_f32 v70, v68, v80
    v_cvt_pk_bf16_f32 v61, v81, v72
    ds_read_b64_tr_b16 v[40:41], v2 offset:40960
    ds_read_b64_tr_b16 v[42:43], v2 offset:41472
    s_waitcnt lgkmcnt(8)
    v_mfma_f32_32x32x16_bf16 v[8:23], a[64:67], v[24:27], v[8:23]
    v_and_b32 v80, s76, v61
    v_sub_f32 v80, v72, v80
    ds_read_b64_tr_b16 v[44:45], v2 offset:43008
    ds_read_b64_tr_b16 v[46:47], v2 offset:43520
    s_waitcnt lgkmcnt(8)
    v_mfma_f32_32x32x16_bf16 v[8:23], a[68:71], v[28:31], v[8:23]
    v_cvt_pk_bf16_f32 v62, v80, 0
    v_mov_b32 v69, v68
    ds_read_b64_tr_b16 v[48:49], v2 offset:45056
    ds_read_b64_tr_b16 v[50:51], v2 offset:45568
    s_waitcnt lgkmcnt(8)
    v_mfma_f32_32x32x16_bf16 v[8:23], a[72:75], v[32:35], v[8:23]
    v_mov_b32 v71, v70
    v_mov_b32 v73, v72
    ds_read_b64_tr_b16 v[52:53], v2 offset:47104
    ds_read_b64_tr_b16 v[54:55], v2 offset:47616
    s_waitcnt lgkmcnt(8)
    v_mfma_f32_32x32x16_bf16 v[8:23], a[76:79], v[36:39], v[8:23]
    v_mov_b32 v64, v60
    v_mov_b32 v65, v61
    ds_read_b64_tr_b16 v[24:25], v2 offset:49152
    ds_read_b64_tr_b16 v[26:27], v2 offset:49664
    s_waitcnt lgkmcnt(8)
    s_waitcnt vmcnt(4)
    v_mfma_f32_32x32x16_bf16 v[8:23], a[80:83], v[40:43], v[8:23]
    v_mov_b32 v66, v62
    ds_read_b64_tr_b16 v[28:29], v2 offset:51200
    ds_read_b64_tr_b16 v[30:31], v2 offset:51712
    s_waitcnt lgkmcnt(8)
    v_mfma_f32_32x32x16_bf16 v[8:23], a[84:87], v[44:47], v[8:23]
    s_nop 1
    ds_read_b64_tr_b16 v[32:33], v2 offset:53248
    ds_read_b64_tr_b16 v[34:35], v2 offset:53760
    s_waitcnt lgkmcnt(8)
    v_mfma_f32_32x32x16_bf16 v[8:23], a[88:91], v[48:51], v[8:23]
    v_permlane32_swap_b32 v68, v69
    ds_read_b64_tr_b16 v[36:37], v2 offset:55296
    ds_read_b64_tr_b16 v[38:39], v2 offset:55808
    s_waitcnt lgkmcnt(8)
    v_mfma_f32_32x32x16_bf16 v[8:23], a[92:95], v[52:55], v[8:23]
    v_permlane32_swap_b32 v70, v71
    s_waitcnt lgkmcnt(6)
    s_waitcnt vmcnt(0)
    v_mfma_f32_32x32x16_bf16 v[8:23], a[96:99], v[24:27], v[8:23]
    v_permlane32_swap_b32 v72, v73
    s_waitcnt lgkmcnt(4)
    v_mfma_f32_32x32x16_bf16 v[8:23], a[100:103], v[28:31], v[8:23]
    v_permlane32_swap_b32 v60, v64
    s_waitcnt lgkmcnt(2)
    v_mfma_f32_32x32x16_bf16 v[8:23], a[104:107], v[32:35], v[8:23]
    v_permlane32_swap_b32 v61, v65
    s_waitcnt lgkmcnt(0)
    v_mfma_f32_32x32x16_bf16 v[8:23], a[108:111], v[36:39], v[8:23]
    v_permlane32_swap_b32 v62, v66
    s_setprio 0
    s_nop 1
    v_mfma_f32_32x32x16_bf16 v[8:23], v[56:59], v[60:63], v[8:23]
    s_nop 11
    v_mul_f32 v24, v8, v8
    v_mul_f32 v25, v9, v9
    v_mul_f32 v26, v10, v10
    v_mul_f32 v27, v11, v11
    v_fma_f32 v24, v24, v70, v68
    v_fma_f32 v25, v25, v70, v68
    v_fma_f32 v26, v26, v70, v68
    v_fma_f32 v27, v27, v70, v68
    v_mul_f32 v24, v24, v8
    v_mul_f32 v25, v25, v9
    v_mul_f32 v26, v26, v10
    v_mul_f32 v27, v27, v11
    v_exp_f32 v24, v24
    v_exp_f32 v25, v25
    v_exp_f32 v26, v26
    v_exp_f32 v27, v27
    s_mov_b32 s6, 0
    buffer_load_dwordx4 a[112:115], v6, s[56:59], s6 offen offset:0 sc1
    v_fma_f32 v24, v24, v72, v72
    v_fma_f32 v25, v25, v72, v72
    v_fma_f32 v26, v26, v72, v72
    v_fma_f32 v27, v27, v72, v72
    v_rcp_f32 v24, v24
    v_rcp_f32 v25, v25
    v_rcp_f32 v26, v26
    v_rcp_f32 v27, v27
    buffer_load_dwordx4 a[116:119], v6, s[56:59], s6 offen offset:1024 sc1
    v_mul_f32 v24, v24, v8
    v_mul_f32 v25, v25, v9
    v_mul_f32 v26, v26, v10
    v_mul_f32 v27, v27, v11
    v_cvt_pk_bf16_f32 v40, v24, v25
    v_cvt_pk_bf16_f32 v41, v26, v27
    v_mul_f32 v28, v12, v12
    v_mul_f32 v29, v13, v13
    v_mul_f32 v30, v14, v14
    v_mul_f32 v31, v15, v15
    v_fma_f32 v28, v28, v70, v68
    v_fma_f32 v29, v29, v70, v68
    v_fma_f32 v30, v30, v70, v68
    v_fma_f32 v31, v31, v70, v68
    v_mul_f32 v28, v28, v12
    v_mul_f32 v29, v29, v13
    v_mul_f32 v30, v30, v14
    v_mul_f32 v31, v31, v15
    v_exp_f32 v28, v28
    v_exp_f32 v29, v29
    v_exp_f32 v30, v30
    v_exp_f32 v31, v31
    buffer_load_dwordx4 a[120:123], v6, s[56:59], s6 offen offset:2048 sc1
    v_fma_f32 v28, v28, v72, v72
    v_fma_f32 v29, v29, v72, v72
    v_fma_f32 v30, v30, v72, v72
    v_fma_f32 v31, v31, v72, v72
    v_rcp_f32 v28, v28
    v_rcp_f32 v29, v29
    v_rcp_f32 v30, v30
    v_rcp_f32 v31, v31
    buffer_load_dwordx4 a[124:127], v6, s[56:59], s6 offen offset:3072 sc1
    v_mul_f32 v28, v28, v12
    v_mul_f32 v29, v29, v13
    v_mul_f32 v30, v30, v14
    v_mul_f32 v31, v31, v15
    v_cvt_pk_bf16_f32 v42, v28, v29
    v_cvt_pk_bf16_f32 v43, v30, v31
    buffer_store_dwordx4 v[40:43], v4, s[56:59], 0 offen offset:0 sc1
    v_mul_f32 v24, v16, v16
    v_mul_f32 v25, v17, v17
    v_mul_f32 v26, v18, v18
    v_mul_f32 v27, v19, v19
    v_fma_f32 v24, v24, v70, v68
    v_fma_f32 v25, v25, v70, v68
    v_fma_f32 v26, v26, v70, v68
    v_fma_f32 v27, v27, v70, v68
    v_mul_f32 v24, v24, v16
    v_mul_f32 v25, v25, v17
    v_mul_f32 v26, v26, v18
    v_mul_f32 v27, v27, v19
    v_exp_f32 v24, v24
    v_exp_f32 v25, v25
    v_exp_f32 v26, v26
    v_exp_f32 v27, v27
    s_mov_b32 s6, 4096
    buffer_load_dwordx4 v[88:91], v6, s[56:59], s6 offen offset:0 sc1
    v_fma_f32 v24, v24, v72, v72
    v_fma_f32 v25, v25, v72, v72
    v_fma_f32 v26, v26, v72, v72
    v_fma_f32 v27, v27, v72, v72
    v_rcp_f32 v24, v24
    v_rcp_f32 v25, v25
    v_rcp_f32 v26, v26
    v_rcp_f32 v27, v27
    buffer_load_dwordx4 v[92:95], v6, s[56:59], s6 offen offset:1024 sc1
    v_mul_f32 v24, v24, v16
    v_mul_f32 v25, v25, v17
    v_mul_f32 v26, v26, v18
    v_mul_f32 v27, v27, v19
    v_cvt_pk_bf16_f32 v44, v24, v25
    v_cvt_pk_bf16_f32 v45, v26, v27
    v_mul_f32 v28, v20, v20
    v_mul_f32 v29, v21, v21
    v_mul_f32 v30, v22, v22
    v_mul_f32 v31, v23, v23
    v_fma_f32 v28, v28, v70, v68
    v_fma_f32 v29, v29, v70, v68
    v_fma_f32 v30, v30, v70, v68
    v_fma_f32 v31, v31, v70, v68
    v_mul_f32 v28, v28, v20
    v_mul_f32 v29, v29, v21
    v_mul_f32 v30, v30, v22
    v_mul_f32 v31, v31, v23
    v_exp_f32 v28, v28
    v_exp_f32 v29, v29
    v_exp_f32 v30, v30
    v_exp_f32 v31, v31
    buffer_load_dwordx4 v[96:99], v6, s[56:59], s6 offen offset:2048 sc1
    v_fma_f32 v28, v28, v72, v72
    v_fma_f32 v29, v29, v72, v72
    v_fma_f32 v30, v30, v72, v72
    v_fma_f32 v31, v31, v72, v72
    v_rcp_f32 v28, v28
    v_rcp_f32 v29, v29
    v_rcp_f32 v30, v30
    v_rcp_f32 v31, v31
    buffer_load_dwordx4 v[100:103], v6, s[56:59], s6 offen offset:3072 sc1
    v_mul_f32 v28, v28, v20
    v_mul_f32 v29, v29, v21
    v_mul_f32 v30, v30, v22
    v_mul_f32 v31, v31, v23
    v_cvt_pk_bf16_f32 v46, v28, v29
    v_cvt_pk_bf16_f32 v47, v30, v31
    buffer_store_dwordx4 v[44:47], v4, s[56:59], 0 offen offset:2048 sc1
    s_setprio 2
    ds_read_b64_tr_b16 v[24:25], v3 offset:0
    ds_read_b64_tr_b16 v[26:27], v3 offset:512
    ds_read_b64_tr_b16 v[28:29], v3 offset:2048
    ds_read_b64_tr_b16 v[30:31], v3 offset:2560
    ds_read_b64_tr_b16 v[32:33], v3 offset:4096
    ds_read_b64_tr_b16 v[34:35], v3 offset:4608
    ds_read_b64_tr_b16 v[36:37], v3 offset:6144
    ds_read_b64_tr_b16 v[38:39], v3 offset:6656
    ds_read_b64_tr_b16 v[40:41], v3 offset:8192
    ds_read_b64_tr_b16 v[42:43], v3 offset:8704
    s_waitcnt lgkmcnt(8)
    v_mfma_f32_32x32x16_bf16 v[8:23], a[0:3], v[24:27], 0
    ds_read_b64_tr_b16 v[44:45], v3 offset:10240
    ds_read_b64_tr_b16 v[46:47], v3 offset:10752
    s_waitcnt lgkmcnt(8)
    v_mfma_f32_32x32x16_bf16 v[8:23], a[4:7], v[28:31], v[8:23]
    s_movk_i32 s6, 8192
    s_mov_b32 s6, 8192
    buffer_load_dwordx4 v[104:107], v6, s[56:59], s6 offen offset:0 sc1
    ds_read_b64_tr_b16 v[48:49], v3 offset:12288
    ds_read_b64_tr_b16 v[50:51], v3 offset:12800
    s_waitcnt lgkmcnt(8)
    v_mfma_f32_32x32x16_bf16 v[8:23], a[8:11], v[32:35], v[8:23]
    ds_read_b64_tr_b16 v[52:53], v3 offset:14336
    ds_read_b64_tr_b16 v[54:55], v3 offset:14848
    s_waitcnt lgkmcnt(8)
    v_mfma_f32_32x32x16_bf16 v[8:23], a[12:15], v[36:39], v[8:23]
    ds_read_b64_tr_b16 v[24:25], v3 offset:16384
    ds_read_b64_tr_b16 v[26:27], v3 offset:16896
    s_waitcnt lgkmcnt(8)
    v_mfma_f32_32x32x16_bf16 v[8:23], a[16:19], v[40:43], v[8:23]
    buffer_load_dwordx4 v[108:111], v6, s[56:59], s6 offen offset:1024 sc1
    ds_read_b64_tr_b16 v[28:29], v3 offset:18432
    ds_read_b64_tr_b16 v[30:31], v3 offset:18944
    s_waitcnt lgkmcnt(8)
    v_mfma_f32_32x32x16_bf16 v[8:23], a[20:23], v[44:47], v[8:23]
    ds_read_b64_tr_b16 v[32:33], v3 offset:20480
    ds_read_b64_tr_b16 v[34:35], v3 offset:20992
    s_waitcnt lgkmcnt(8)
    v_mfma_f32_32x32x16_bf16 v[8:23], a[24:27], v[48:51], v[8:23]
    ds_read_b64_tr_b16 v[36:37], v3 offset:22528
    ds_read_b64_tr_b16 v[38:39], v3 offset:23040
    s_waitcnt lgkmcnt(8)
    v_mfma_f32_32x32x16_bf16 v[8:23], a[28:31], v[52:55], v[8:23]
    buffer_load_dwordx4 v[112:115], v6, s[56:59], s6 offen offset:2048 sc1
    ds_read_b64_tr_b16 v[40:41], v3 offset:24576
    ds_read_b64_tr_b16 v[42:43], v3 offset:25088
    s_waitcnt lgkmcnt(8)
    v_mfma_f32_32x32x16_bf16 v[8:23], a[32:35], v[24:27], v[8:23]
    ds_read_b64_tr_b16 v[44:45], v3 offset:26624
    ds_read_b64_tr_b16 v[46:47], v3 offset:27136
    s_waitcnt lgkmcnt(8)
    v_mfma_f32_32x32x16_bf16 v[8:23], a[36:39], v[28:31], v[8:23]
    ds_read_b64_tr_b16 v[48:49], v3 offset:28672
    ds_read_b64_tr_b16 v[50:51], v3 offset:29184
    s_waitcnt lgkmcnt(8)
    v_mfma_f32_32x32x16_bf16 v[8:23], a[40:43], v[32:35], v[8:23]
    buffer_load_dwordx4 v[116:119], v6, s[56:59], s6 offen offset:3072 sc1
    ds_read_b64_tr_b16 v[52:53], v3 offset:30720
    ds_read_b64_tr_b16 v[54:55], v3 offset:31232
    s_waitcnt lgkmcnt(8)
    v_mfma_f32_32x32x16_bf16 v[8:23], a[44:47], v[36:39], v[8:23]
    ds_read_b64_tr_b16 v[24:25], v3 offset:32768
    ds_read_b64_tr_b16 v[26:27], v3 offset:33280
    s_waitcnt lgkmcnt(8)
    v_mfma_f32_32x32x16_bf16 v[8:23], a[48:51], v[40:43], v[8:23]
    ds_read_b64_tr_b16 v[28:29], v3 offset:34816
    ds_read_b64_tr_b16 v[30:31], v3 offset:35328
    s_waitcnt lgkmcnt(8)
    v_mfma_f32_32x32x16_bf16 v[8:23], a[52:55], v[44:47], v[8:23]
    s_mov_b32 s6, 12288
    buffer_load_dwordx4 v[120:123], v6, s[56:59], s6 offen offset:0 sc1
    ds_read_b64_tr_b16 v[32:33], v3 offset:36864
    ds_read_b64_tr_b16 v[34:35], v3 offset:37376
    s_waitcnt lgkmcnt(8)
    v_mfma_f32_32x32x16_bf16 v[8:23], a[56:59], v[48:51], v[8:23]
    ds_read_b64_tr_b16 v[36:37], v3 offset:38912
    ds_read_b64_tr_b16 v[38:39], v3 offset:39424
    s_waitcnt lgkmcnt(8)
    v_mfma_f32_32x32x16_bf16 v[8:23], a[60:63], v[52:55], v[8:23]
    ds_read_b64_tr_b16 v[40:41], v3 offset:40960
    ds_read_b64_tr_b16 v[42:43], v3 offset:41472
    s_waitcnt lgkmcnt(8)
    v_mfma_f32_32x32x16_bf16 v[8:23], a[64:67], v[24:27], v[8:23]
    buffer_load_dwordx4 v[124:127], v6, s[56:59], s6 offen offset:1024 sc1
    ds_read_b64_tr_b16 v[44:45], v3 offset:43008
    ds_read_b64_tr_b16 v[46:47], v3 offset:43520
    s_waitcnt lgkmcnt(8)
    v_mfma_f32_32x32x16_bf16 v[8:23], a[68:71], v[28:31], v[8:23]
    ds_read_b64_tr_b16 v[48:49], v3 offset:45056
    ds_read_b64_tr_b16 v[50:51], v3 offset:45568
    s_waitcnt lgkmcnt(8)
    v_mfma_f32_32x32x16_bf16 v[8:23], a[72:75], v[32:35], v[8:23]
    ds_read_b64_tr_b16 v[52:53], v3 offset:47104
    ds_read_b64_tr_b16 v[54:55], v3 offset:47616
    s_waitcnt lgkmcnt(8)
    v_mfma_f32_32x32x16_bf16 v[8:23], a[76:79], v[36:39], v[8:23]
    ds_read_b64_tr_b16 v[24:25], v3 offset:49152
    ds_read_b64_tr_b16 v[26:27], v3 offset:49664
    s_waitcnt lgkmcnt(8)
    v_mfma_f32_32x32x16_bf16 v[8:23], a[80:83], v[40:43], v[8:23]
    ds_read_b64_tr_b16 v[28:29], v3 offset:51200
    ds_read_b64_tr_b16 v[30:31], v3 offset:51712
    s_waitcnt lgkmcnt(8)
    v_mfma_f32_32x32x16_bf16 v[8:23], a[84:87], v[44:47], v[8:23]
    ds_read_b64_tr_b16 v[32:33], v3 offset:53248
    ds_read_b64_tr_b16 v[34:35], v3 offset:53760
    s_waitcnt lgkmcnt(8)
    v_mfma_f32_32x32x16_bf16 v[8:23], a[88:91], v[48:51], v[8:23]
    ds_read_b64_tr_b16 v[36:37], v3 offset:55296
    ds_read_b64_tr_b16 v[38:39], v3 offset:55808
    s_waitcnt lgkmcnt(8)
    v_mfma_f32_32x32x16_bf16 v[8:23], a[92:95], v[52:55], v[8:23]
    s_waitcnt lgkmcnt(6)
    v_mfma_f32_32x32x16_bf16 v[8:23], a[96:99], v[24:27], v[8:23]
    s_waitcnt lgkmcnt(4)
    v_mfma_f32_32x32x16_bf16 v[8:23], a[100:103], v[28:31], v[8:23]
    s_waitcnt lgkmcnt(2)
    v_mfma_f32_32x32x16_bf16 v[8:23], a[104:107], v[32:35], v[8:23]
    s_waitcnt lgkmcnt(0)
    v_mfma_f32_32x32x16_bf16 v[8:23], a[108:111], v[36:39], v[8:23]
    s_setprio 0
    s_nop 1
    v_mfma_f32_32x32x16_bf16 v[8:23], v[56:59], v[64:67], v[8:23]
    v_mov_b32 v76, v69
    v_mov_b32 v77, v69
    v_mov_b32 v78, v71
    v_mov_b32 v79, v71
    v_mov_b32 v80, v73
    v_mov_b32 v81, v73
    s_nop 5
    v_pk_mul_f32 v[24:25], v[8:9], v[8:9]
    v_pk_mul_f32 v[26:27], v[10:11], v[10:11]
    v_pk_fma_f32 v[24:25], v[24:25], v[78:79], v[76:77]
    v_pk_fma_f32 v[26:27], v[26:27], v[78:79], v[76:77]
    v_pk_mul_f32 v[24:25], v[24:25], v[8:9]
    v_pk_mul_f32 v[26:27], v[26:27], v[10:11]
    v_exp_f32 v24, v24
    v_exp_f32 v25, v25
    v_exp_f32 v26, v26
    v_exp_f32 v27, v27
    v_pk_fma_f32 v[24:25], v[24:25], v[80:81], v[80:81]
    v_pk_fma_f32 v[26:27], v[26:27], v[80:81], v[80:81]
    v_rcp_f32 v24, v24
    v_rcp_f32 v25, v25
    v_rcp_f32 v26, v26
    v_rcp_f32 v27, v27
    v_pk_mul_f32 v[24:25], v[24:25], v[8:9]
    v_pk_mul_f32 v[26:27], v[26:27], v[10:11]
    v_cvt_pk_bf16_f32 v40, v24, v25
    v_cvt_pk_bf16_f32 v41, v26, v27
    v_pk_mul_f32 v[28:29], v[12:13], v[12:13]
    v_pk_mul_f32 v[30:31], v[14:15], v[14:15]
    v_pk_fma_f32 v[28:29], v[28:29], v[78:79], v[76:77]
    v_pk_fma_f32 v[30:31], v[30:31], v[78:79], v[76:77]
    v_pk_mul_f32 v[28:29], v[28:29], v[12:13]
    v_pk_mul_f32 v[30:31], v[30:31], v[14:15]
    v_exp_f32 v28, v28
    v_exp_f32 v29, v29
    v_exp_f32 v30, v30
    v_exp_f32 v31, v31
    v_pk_fma_f32 v[28:29], v[28:29], v[80:81], v[80:81]
    v_pk_fma_f32 v[30:31], v[30:31], v[80:81], v[80:81]
    v_rcp_f32 v28, v28
    v_rcp_f32 v29, v29
    v_rcp_f32 v30, v30
    v_rcp_f32 v31, v31
    v_pk_mul_f32 v[28:29], v[28:29], v[12:13]
    v_pk_mul_f32 v[30:31], v[30:31], v[14:15]
    v_cvt_pk_bf16_f32 v42, v28, v29
    v_cvt_pk_bf16_f32 v43, v30, v31
    buffer_store_dwordx4 v[40:43], v4, s[56:59], 0 offen offset:1024 sc1
    v_pk_mul_f32 v[24:25], v[16:17], v[16:17]
    v_pk_mul_f32 v[26:27], v[18:19], v[18:19]
    v_pk_fma_f32 v[24:25], v[24:25], v[78:79], v[76:77]
    v_pk_fma_f32 v[26:27], v[26:27], v[78:79], v[76:77]
    v_pk_mul_f32 v[24:25], v[24:25], v[16:17]
    v_pk_mul_f32 v[26:27], v[26:27], v[18:19]
    v_exp_f32 v24, v24
    v_exp_f32 v25, v25
    v_exp_f32 v26, v26
    v_exp_f32 v27, v27
    v_pk_fma_f32 v[24:25], v[24:25], v[80:81], v[80:81]
    v_pk_fma_f32 v[26:27], v[26:27], v[80:81], v[80:81]
    v_rcp_f32 v24, v24
    v_rcp_f32 v25, v25
    v_rcp_f32 v26, v26
    v_rcp_f32 v27, v27
    v_pk_mul_f32 v[24:25], v[24:25], v[16:17]
    v_pk_mul_f32 v[26:27], v[26:27], v[18:19]
    v_cvt_pk_bf16_f32 v44, v24, v25
    v_cvt_pk_bf16_f32 v45, v26, v27
    v_pk_mul_f32 v[28:29], v[20:21], v[20:21]
    v_pk_mul_f32 v[30:31], v[22:23], v[22:23]
    v_pk_fma_f32 v[28:29], v[28:29], v[78:79], v[76:77]
    v_pk_fma_f32 v[30:31], v[30:31], v[78:79], v[76:77]
    v_pk_mul_f32 v[28:29], v[28:29], v[20:21]
    v_pk_mul_f32 v[30:31], v[30:31], v[22:23]
    v_exp_f32 v28, v28
    v_exp_f32 v29, v29
    v_exp_f32 v30, v30
    v_exp_f32 v31, v31
    v_pk_fma_f32 v[28:29], v[28:29], v[80:81], v[80:81]
    v_pk_fma_f32 v[30:31], v[30:31], v[80:81], v[80:81]
    v_rcp_f32 v28, v28
    v_rcp_f32 v29, v29
    v_rcp_f32 v30, v30
    v_rcp_f32 v31, v31
    v_pk_mul_f32 v[28:29], v[28:29], v[20:21]
    v_pk_mul_f32 v[30:31], v[30:31], v[22:23]
    v_cvt_pk_bf16_f32 v46, v28, v29
    v_cvt_pk_bf16_f32 v47, v30, v31
    buffer_store_dwordx4 v[44:47], v4, s[56:59], 0 offen offset:3072 sc1
    s_mul_i32 s4, s73, 112
    s_mul_i32 s5, s61, 14
    s_add_u32 s4, s4, s5
    s_lshl_b32 s4, s4, 11
    s_add_u32 s4, s4, 8863744
    v_lshl_add_u32 v4, v1, 4, s4
    v_and_b32 v3, 31, v1
    v_lshrrev_b32 v5, 5, v1
    v_and_b32 v2, 7, v1
    v_xor_b32 v5, v5, v2
    v_lshlrev_b32 v5, 4, v5
    v_lshl_add_u32 v3, v3, 8, v5
    s_lshl_b32 s5, s3, 14
    v_add_u32 v3, s5, v3
    s_waitcnt vmcnt(0)
    s_barrier
    s_mov_b32 s6, 12288
    buffer_load_dwordx4 a[0:3], v6, s[56:59], s6 offen offset:2048 sc1
    buffer_load_dwordx4 a[4:7], v6, s[56:59], s6 offen offset:3072 sc1
    s_mov_b32 s6, 16384
    buffer_load_dwordx4 a[8:11], v6, s[56:59], s6 offen offset:0 sc1
    buffer_load_dwordx4 a[12:15], v6, s[56:59], s6 offen offset:1024 sc1
    buffer_load_dwordx4 a[16:19], v6, s[56:59], s6 offen offset:2048 sc1
    buffer_load_dwordx4 a[20:23], v6, s[56:59], s6 offen offset:3072 sc1
    s_mov_b32 s6, 20480
    buffer_load_dwordx4 a[24:27], v6, s[56:59], s6 offen offset:0 sc1
    buffer_load_dwordx4 a[28:31], v6, s[56:59], s6 offen offset:1024 sc1
    buffer_load_dwordx4 a[32:35], v6, s[56:59], s6 offen offset:2048 sc1
    buffer_load_dwordx4 a[36:39], v6, s[56:59], s6 offen offset:3072 sc1
    s_mov_b32 s6, 24576
    buffer_load_dwordx4 a[40:43], v6, s[56:59], s6 offen offset:0 sc1
    buffer_load_dwordx4 a[44:47], v6, s[56:59], s6 offen offset:1024 sc1
    buffer_load_dwordx4 a[48:51], v6, s[56:59], s6 offen offset:2048 sc1
    buffer_load_dwordx4 a[52:55], v6, s[56:59], s6 offen offset:3072 sc1
    s_barrier
    s_barrier
    s_mov_b32 s4, 0
    buffer_load_dwordx4 a[56:59], v4, s[56:59], s4 offen offset:0 sc1
    buffer_load_dwordx4 a[60:63], v4, s[56:59], s4 offen offset:1024 sc1
    buffer_load_dwordx4 a[64:67], v4, s[56:59], s4 offen offset:2048 sc1
    buffer_load_dwordx4 a[68:71], v4, s[56:59], s4 offen offset:3072 sc1
    s_mov_b32 s4, 4096
    buffer_load_dwordx4 a[72:75], v4, s[56:59], s4 offen offset:0 sc1
    buffer_load_dwordx4 a[76:79], v4, s[56:59], s4 offen offset:1024 sc1
    buffer_load_dwordx4 a[80:83], v4, s[56:59], s4 offen offset:2048 sc1
    buffer_load_dwordx4 a[84:87], v4, s[56:59], s4 offen offset:3072 sc1
    s_mov_b32 s4, 8192
    buffer_load_dwordx4 a[88:91], v4, s[56:59], s4 offen offset:0 sc1
    buffer_load_dwordx4 a[92:95], v4, s[56:59], s4 offen offset:1024 sc1
    buffer_load_dwordx4 a[96:99], v4, s[56:59], s4 offen offset:2048 sc1
    buffer_load_dwordx4 a[100:103], v4, s[56:59], s4 offen offset:3072 sc1
    s_mov_b32 s4, 12288
    buffer_load_dwordx4 a[104:107], v4, s[56:59], s4 offen offset:0 sc1
    buffer_load_dwordx4 a[108:111], v4, s[56:59], s4 offen offset:1024 sc1
    buffer_load_dwordx4 v[72:75], v4, s[56:59], s4 offen offset:2048 sc1
    buffer_load_dwordx4 v[76:79], v4, s[56:59], s4 offen offset:3072 sc1
    s_mov_b32 s4, 16384
    buffer_load_dwordx4 v[80:83], v4, s[56:59], s4 offen offset:0 sc1
    buffer_load_dwordx4 v[84:87], v4, s[56:59], s4 offen offset:1024 sc1
    s_waitcnt vmcnt(16)
    v_mfma_f32_32x32x16_bf16 v[8:23], a[112:115], a[56:59], 0
    v_mfma_f32_32x32x16_bf16 v[40:55], a[116:119], a[56:59], 0
    v_mfma_f32_32x32x16_bf16 v[24:39], a[112:115], a[60:63], 0
    v_mfma_f32_32x32x16_bf16 v[56:71], a[116:119], a[60:63], 0
    s_mov_b32 s4, 16384
    buffer_load_dwordx4 a[56:59], v4, s[56:59], s4 offen offset:2048 sc1
    buffer_load_dwordx4 a[60:63], v4, s[56:59], s4 offen offset:3072 sc1
    s_waitcnt vmcnt(16)
    v_mfma_f32_32x32x16_bf16 v[8:23], a[120:123], a[64:67], v[8:23]
    v_mfma_f32_32x32x16_bf16 v[40:55], a[124:127], a[64:67], v[40:55]
    v_mfma_f32_32x32x16_bf16 v[24:39], a[120:123], a[68:71], v[24:39]
    v_mfma_f32_32x32x16_bf16 v[56:71], a[124:127], a[68:71], v[56:71]
    s_mov_b32 s4, 20480
    buffer_load_dwordx4 a[64:67], v4, s[56:59], s4 offen offset:0 sc1
    buffer_load_dwordx4 a[68:71], v4, s[56:59], s4 offen offset:1024 sc1
    s_waitcnt vmcnt(16)
    v_mfma_f32_32x32x16_bf16 v[8:23], v[88:91], a[72:75], v[8:23]
    v_mfma_f32_32x32x16_bf16 v[40:55], v[92:95], a[72:75], v[40:55]
    v_mfma_f32_32x32x16_bf16 v[24:39], v[88:91], a[76:79], v[24:39]
    v_mfma_f32_32x32x16_bf16 v[56:71], v[92:95], a[76:79], v[56:71]
    buffer_load_dwordx4 a[72:75], v4, s[56:59], s4 offen offset:2048 sc1
    buffer_load_dwordx4 a[76:79], v4, s[56:59], s4 offen offset:3072 sc1
    s_waitcnt vmcnt(16)
    v_mfma_f32_32x32x16_bf16 v[8:23], v[96:99], a[80:83], v[8:23]
    v_mfma_f32_32x32x16_bf16 v[40:55], v[100:103], a[80:83], v[40:55]
    v_mfma_f32_32x32x16_bf16 v[24:39], v[96:99], a[84:87], v[24:39]
    v_mfma_f32_32x32x16_bf16 v[56:71], v[100:103], a[84:87], v[56:71]
    s_mov_b32 s4, 24576
    buffer_load_dwordx4 a[80:83], v4, s[56:59], s4 offen offset:0 sc1
    buffer_load_dwordx4 a[84:87], v4, s[56:59], s4 offen offset:1024 sc1
    s_waitcnt vmcnt(16)
    v_mfma_f32_32x32x16_bf16 v[8:23], v[104:107], a[88:91], v[8:23]
    v_mfma_f32_32x32x16_bf16 v[40:55], v[108:111], a[88:91], v[40:55]
    v_mfma_f32_32x32x16_bf16 v[24:39], v[104:107], a[92:95], v[24:39]
    v_mfma_f32_32x32x16_bf16 v[56:71], v[108:111], a[92:95], v[56:71]
    buffer_load_dwordx4 a[88:91], v4, s[56:59], s4 offen offset:2048 sc1
    buffer_load_dwordx4 a[92:95], v4, s[56:59], s4 offen offset:3072 sc1
    s_waitcnt vmcnt(16)
    v_mfma_f32_32x32x16_bf16 v[8:23], v[112:115], a[96:99], v[8:23]
    v_mfma_f32_32x32x16_bf16 v[40:55], v[116:119], a[96:99], v[40:55]
    v_mfma_f32_32x32x16_bf16 v[24:39], v[112:115], a[100:103], v[24:39]
    v_mfma_f32_32x32x16_bf16 v[56:71], v[116:119], a[100:103], v[56:71]
    s_waitcnt vmcnt(14)
    v_mfma_f32_32x32x16_bf16 v[8:23], v[120:123], a[104:107], v[8:23]
    v_mfma_f32_32x32x16_bf16 v[40:55], v[124:127], a[104:107], v[40:55]
    v_mfma_f32_32x32x16_bf16 v[24:39], v[120:123], a[108:111], v[24:39]
    v_mfma_f32_32x32x16_bf16 v[56:71], v[124:127], a[108:111], v[56:71]
    s_waitcnt vmcnt(12)
    v_mfma_f32_32x32x16_bf16 v[8:23], a[0:3], v[72:75], v[8:23]
    v_mfma_f32_32x32x16_bf16 v[40:55], a[4:7], v[72:75], v[40:55]
    v_mfma_f32_32x32x16_bf16 v[24:39], a[0:3], v[76:79], v[24:39]
    v_mfma_f32_32x32x16_bf16 v[56:71], a[4:7], v[76:79], v[56:71]
    s_waitcnt vmcnt(10)
    v_mfma_f32_32x32x16_bf16 v[8:23], a[8:11], v[80:83], v[8:23]
    v_mfma_f32_32x32x16_bf16 v[40:55], a[12:15], v[80:83], v[40:55]
    v_mfma_f32_32x32x16_bf16 v[24:39], a[8:11], v[84:87], v[24:39]
    v_mfma_f32_32x32x16_bf16 v[56:71], a[12:15], v[84:87], v[56:71]
    s_waitcnt vmcnt(8)
    v_mfma_f32_32x32x16_bf16 v[8:23], a[16:19], a[56:59], v[8:23]
    v_mfma_f32_32x32x16_bf16 v[40:55], a[20:23], a[56:59], v[40:55]
    v_mfma_f32_32x32x16_bf16 v[24:39], a[16:19], a[60:63], v[24:39]
    v_mfma_f32_32x32x16_bf16 v[56:71], a[20:23], a[60:63], v[56:71]
    s_waitcnt vmcnt(6)
    v_mfma_f32_32x32x16_bf16 v[8:23], a[24:27], a[64:67], v[8:23]
    v_mfma_f32_32x32x16_bf16 v[40:55], a[28:31], a[64:67], v[40:55]
    v_mfma_f32_32x32x16_bf16 v[24:39], a[24:27], a[68:71], v[24:39]
    v_mfma_f32_32x32x16_bf16 v[56:71], a[28:31], a[68:71], v[56:71]
    s_waitcnt vmcnt(4)
    v_mfma_f32_32x32x16_bf16 v[8:23], a[32:35], a[72:75], v[8:23]
    v_mfma_f32_32x32x16_bf16 v[40:55], a[36:39], a[72:75], v[40:55]
    v_mfma_f32_32x32x16_bf16 v[24:39], a[32:35], a[76:79], v[24:39]
    v_mfma_f32_32x32x16_bf16 v[56:71], a[36:39], a[76:79], v[56:71]
    s_waitcnt vmcnt(2)
    v_mfma_f32_32x32x16_bf16 v[8:23], a[40:43], a[80:83], v[8:23]
    v_mfma_f32_32x32x16_bf16 v[40:55], a[44:47], a[80:83], v[40:55]
    v_mfma_f32_32x32x16_bf16 v[24:39], a[40:43], a[84:87], v[24:39]
    v_mfma_f32_32x32x16_bf16 v[56:71], a[44:47], a[84:87], v[56:71]
    s_waitcnt vmcnt(0)
    v_mfma_f32_32x32x16_bf16 v[8:23], a[48:51], a[88:91], v[8:23]
    v_mfma_f32_32x32x16_bf16 v[40:55], a[52:55], a[88:91], v[40:55]
    v_mfma_f32_32x32x16_bf16 v[24:39], a[48:51], a[92:95], v[24:39]
    v_mfma_f32_32x32x16_bf16 v[56:71], a[52:55], a[92:95], v[56:71]
    s_branch G2_WR
AUXQ:
    s_mov_b32 s6, s11
    v_lshrrev_b32 v2, 4, v1
    v_bfe_u32 v3, v1, 2, 2
    v_and_b32 v7, 3, v1
    v_lshl_add_u32 v13, v2, 3, v3
    v_lshlrev_b32 v60, 6, v13
    v_lshl_add_u32 v60, v7, 3, v60
    v_and_b32 v13, 15, v1
    v_lshlrev_b32 v61, 12, v13
    v_lshl_add_u32 v61, v2, 4, v61
    s_lshl_b32 s4, s69, 18
    s_lshl_b32 s5, s7, 17
    s_add_u32 s4, s4, s5
    s_lshl_b32 s5, s68, 7
    s_add_u32 s4, s4, s5
    s_add_u32 s4, s4, 1900544
    v_add_u32 v61, s4, v61
    v_add_u32 v62, 0x10000, v61
    s_lshl_b32 s4, s7, 12
    s_add_u32 s4, s4, 75776
    v_add_u32 v60, s4, v60
    s_waitcnt vmcnt(0)
    ds_read_b64_tr_b16 v[64:65], v60 offset:0
    ds_read_b64_tr_b16 v[66:67], v60 offset:256
    ds_read_b64_tr_b16 v[68:69], v60 offset:2048
    ds_read_b64_tr_b16 v[70:71], v60 offset:2304
    ds_read_b64_tr_b16 v[72:73], v60 offset:32
    ds_read_b64_tr_b16 v[74:75], v60 offset:288
    ds_read_b64_tr_b16 v[76:77], v60 offset:2080
    ds_read_b64_tr_b16 v[78:79], v60 offset:2336
    s_cmp_lt_u32 s6, 256
    s_cbranch_scc0 Q_NOSTAT
    s_mov_b32 s4, 0x3f803f80
    v_mov_b32 v26, 0
    v_mov_b32 v27, 0
    v_mov_b32 v28, 0
    v_mov_b32 v29, 0
    v_dot2_f32_bf16 v26, v32, s4, v26
    v_dot2_f32_bf16 v28, v32, v32, v28
    v_dot2_f32_bf16 v27, v33, s4, v27
    v_dot2_f32_bf16 v29, v33, v33, v29
    v_dot2_f32_bf16 v26, v34, s4, v26
    v_dot2_f32_bf16 v28, v34, v34, v28
    v_dot2_f32_bf16 v27, v35, s4, v27
    v_dot2_f32_bf16 v29, v35, v35, v29
    v_dot2_f32_bf16 v26, v36, s4, v26
    v_dot2_f32_bf16 v28, v36, v36, v28
    v_dot2_f32_bf16 v27, v37, s4, v27
    v_dot2_f32_bf16 v29, v37, v37, v29
    v_dot2_f32_bf16 v26, v38, s4, v26
    v_dot2_f32_bf16 v28, v38, v38, v28
    v_dot2_f32_bf16 v27, v39, s4, v27
    v_dot2_f32_bf16 v29, v39, v39, v29
    v_dot2_f32_bf16 v26, v40, s4, v26
    v_dot2_f32_bf16 v28, v40, v40, v28
    v_dot2_f32_bf16 v27, v41, s4, v27
    v_dot2_f32_bf16 v29, v41, v41, v29
    v_dot2_f32_bf16 v26, v42, s4, v26
    v_dot2_f32_bf16 v28, v42, v42, v28
    v_dot2_f32_bf16 v27, v43, s4, v27
    v_dot2_f32_bf16 v29, v43, v43, v29
    v_dot2_f32_bf16 v26, v44, s4, v26
    v_dot2_f32_bf16 v28, v44, v44, v28
    v_dot2_f32_bf16 v27, v45, s4, v27
    v_dot2_f32_bf16 v29, v45, v45, v29
    v_dot2_f32_bf16 v26, v46, s4, v26
    v_dot2_f32_bf16 v28, v46, v46, v28
    v_dot2_f32_bf16 v27, v47, s4, v27
    v_dot2_f32_bf16 v29, v47, v47, v29
    v_dot2_f32_bf16 v26, v48, s4, v26
    v_dot2_f32_bf16 v28, v48, v48, v28
    v_dot2_f32_bf16 v27, v49, s4, v27
    v_dot2_f32_bf16 v29, v49, v49, v29
    v_dot2_f32_bf16 v26, v50, s4, v26
    v_dot2_f32_bf16 v28, v50, v50, v28
    v_dot2_f32_bf16 v27, v51, s4, v27
    v_dot2_f32_bf16 v29, v51, v51, v29
    v_dot2_f32_bf16 v26, v52, s4, v26
    v_dot2_f32_bf16 v28, v52, v52, v28
    v_dot2_f32_bf16 v27, v53, s4, v27
    v_dot2_f32_bf16 v29, v53, v53, v29
    v_dot2_f32_bf16 v26, v54, s4, v26
    v_dot2_f32_bf16 v28, v54, v54, v28
    v_dot2_f32_bf16 v27, v55, s4, v27
    v_dot2_f32_bf16 v29, v55, v55, v29
    v_dot2_f32_bf16 v26, v56, s4, v26
    v_dot2_f32_bf16 v28, v56, v56, v28
    v_dot2_f32_bf16 v27, v57, s4, v27
    v_dot2_f32_bf16 v29, v57, v57, v29
    v_dot2_f32_bf16 v26, v58, s4, v26
    v_dot2_f32_bf16 v28, v58, v58, v28
    v_dot2_f32_bf16 v27, v59, s4, v27
    v_dot2_f32_bf16 v29, v59, v59, v29
    s_nop 2
    v_add_f32 v26, v26, v27
    v_add_f32 v28, v28, v29
    s_nop 1
    v_add_f32_dpp v26, v26, v26 quad_perm:[1,0,3,2] row_mask:0xf bank_mask:0xf
    v_add_f32_dpp v28, v28, v28 quad_perm:[1,0,3,2] row_mask:0xf bank_mask:0xf
    s_nop 1
    v_add_f32_dpp v26, v26, v26 quad_perm:[2,3,0,1] row_mask:0xf bank_mask:0xf
    v_add_f32_dpp v28, v28, v28 quad_perm:[2,3,0,1] row_mask:0xf bank_mask:0xf
    s_nop 1
    v_add_f32_dpp v26, v26, v26 row_half_mirror row_mask:0xf bank_mask:0xf
    v_add_f32_dpp v28, v28, v28 row_half_mirror row_mask:0xf bank_mask:0xf
    v_mul_f32 v26, 0x3b124925, v26
    v_mul_f32 v28, 0x3b124925, v28
    v_fma_f32 v28, -v26, v26, v28
    v_max_f32 v28, 0, v28
    v_add_f32 v28, 0x3727c5ac, v28
    v_rsq_f32 v28, v28
    s_lshl_b32 s4, s6, 6
    s_add_u32 s4, s4, 5570560
    v_lshrrev_b32 v2, 3, v1
    v_lshl_add_u32 v2, v2, 2, s4
    v_and_b32 v3, 1, v1
    v_lshl_add_u32 v2, v3, 5, v2
    v_cmp_eq_u32 vcc, 1, v3
    v_mul_f32 v26, v26, v28
    v_sub_f32 v26, 0, v26
    v_cndmask_b32 v28, v28, v26, vcc
    s_mov_b32 exec_lo, 0x03030303
    s_mov_b32 exec_hi, 0x03030303
    buffer_store_dword v28, v2, s[56:59], 0 offen sc1
    s_mov_b64 exec, -1
Q_NOSTAT:
    s_waitcnt lgkmcnt(0)
    buffer_store_dwordx4 v[64:67], v61, s[56:59], 0 offen offset:0 sc1
    buffer_store_dwordx4 v[68:71], v61, s[56:59], 0 offen offset:64 sc1
    buffer_store_dwordx4 v[72:75], v62, s[56:59], 0 offen offset:0 sc1
    buffer_store_dwordx4 v[76:79], v62, s[56:59], 0 offen offset:64 sc1
    v_lshlrev_b32 v15, 4, v1
    s_lshl_b32 s4, s72, 13
    s_lshl_b32 s5, s7, 12
    s_add_u32 s4, s4, s5
    s_add_u32 s4, s4, 1900544
    v_add_u32 v16, s4, v15
    s_lshl_b32 s4, s7, 13
    s_add_u32 s4, s4, 5570560
    v_add_u32 v17, s4, v15
    v_add_u32 v18, 4096, v17
    s_and_b32 s6, s2, 7
    s_lshl_b32 s6, s6, 8
    s_add_u32 s6, s6, 6144
    s_load_dword s67, s[52:53], 0
    s_waitcnt vmcnt(0) lgkmcnt(0)
    s_mov_b32 s77, 262144
INIT_11:
    s_cmp_lg_u32 s67, 0
    s_cbranch_scc1 INITOK_12
    v_mov_b32 v2, 0
    buffer_load_dword v3, v2, s[52:55], 0 offen sc1
    s_waitcnt vmcnt(0)
    v_readfirstlane_b32 s67, v3
    s_sub_u32 s77, s77, 1
    s_cbranch_scc0 INIT_11
INITOK_12:
    v_mov_b32 v2, 139268
    v_mov_b32 v3, 1
    s_mov_b64 exec, 1
    ds_add_rtn_u32 v3, v2, v3
    s_waitcnt lgkmcnt(0)
    s_mov_b64 exec, -1
    v_readfirstlane_b32 s75, v3
    s_cmp_lg_u32 s75, 3
    s_cbranch_scc1 Q_SB_DONE
    s_mov_b32 s75, 1
    s_atomic_add s75, s[56:57], s6 glc
    s_waitcnt lgkmcnt(0)
    s_cmp_lg_u32 s75, 27
    s_cbranch_scc1 ARR_13
    s_mov_b32 s75, 1
    s_atomic_add s75, s[56:57], 8192
    s_atomic_add s75, s[56:57], 8448
    s_atomic_add s75, s[56:57], 8704
    s_atomic_add s75, s[56:57], 8960
    s_atomic_add s75, s[56:57], 9216
    s_atomic_add s75, s[56:57], 9472
    s_atomic_add s75, s[56:57], 9728
    s_atomic_add s75, s[56:57], 9984
    s_waitcnt lgkmcnt(0)
ARR_13:
Q_SB_DONE:
    s_lshl_b32 s4, s74, 3
    s_add_u32 s4, s4, s60
    s_mul_i32 s5, s4, 28672
    s_add_u32 s5, s5, 5652480
    v_lshl_add_u32 v86, v1, 4, s5
    s_lshl_b32 s4, s4, 6
    v_and_b32 v14, 31, v1
    v_lshl_add_u32 v14, v14, 1, s4
    v_lshrrev_b32 v3, 5, v1
    v_mul_u32_u24 v12, 28672, v3
    v_lshl_add_u32 v12, v14, 1, v12
    v_add_u32 v12, 5586944, v12
    s_mul_i32 s4, s74, 112
    s_mul_i32 s5, s61, 14
    s_add_u32 s4, s4, s5
    s_lshl_b32 s4, s4, 11
    s_add_u32 s4, s4, 7258112
    v_lshl_add_u32 v6, v1, 4, s4
    s_barrier
    s_and_b32 s6, s2, 7
    s_lshl_b32 s6, s6, 8
    s_add_u32 s6, s6, 8192
    v_mov_b32 v2, s6
    s_lshl_b32 s4, s7, 12
    s_add_u32 s4, s4, 42240
    s_mov_b32 m0, s4
    s_lshl_b32 s4, s7, 13
    s_add_u32 s4, s4, 98304
    s_mov_b32 s77, 262144
POLL_14:
    buffer_load_dword v3, v2, s[56:59], 0 offen sc1
    s_waitcnt vmcnt(0)
    v_readfirstlane_b32 s75, v3
    s_cmp_ge_u32 s75, 8
    s_cbranch_scc1 POLLD_15
    s_sub_u32 s77, s77, 1
    s_cbranch_scc0 POLL_14
    v_mov_b32 v3, 91
    v_mov_b32 v2, 4
    buffer_store_dword v3, v2, s[52:55], 0 offen
POLLD_15:
    buffer_load_dwordx4 v16, s[56:59], 0 offen offset:0 sc1 lds
    buffer_load_dwordx4 v16, s[56:59], 0 offen offset:1024 sc1 lds
    buffer_load_dwordx4 v16, s[56:59], 0 offen offset:2048 sc1 lds
    buffer_load_dwordx4 v16, s[56:59], 0 offen offset:3072 sc1 lds
    s_mov_b32 m0, s4
    s_add_u32 s4, s4, 4096
    buffer_load_dwordx4 v17, s[56:59], 0 offen offset:0 sc1 lds
    buffer_load_dwordx4 v17, s[56:59], 0 offen offset:1024 sc1 lds
    buffer_load_dwordx4 v17, s[56:59], 0 offen offset:2048 sc1 lds
    buffer_load_dwordx4 v17, s[56:59], 0 offen offset:3072 sc1 lds
    s_mov_b32 m0, s4
    s_nop 0
    buffer_load_dwordx4 v18, s[56:59], 0 offen offset:0 sc1 lds
    buffer_load_dwordx4 v18, s[56:59], 0 offen offset:1024 sc1 lds
    buffer_load_dwordx4 v18, s[56:59], 0 offen offset:2048 sc1 lds
    buffer_load_dwordx4 v18, s[56:59], 0 offen offset:3072 sc1 lds
    v_mov_b32 v2, 139292
    v_mov_b32 v3, 1
    s_mov_b64 exec, 1
    ds_add_u32 v2, v3
    s_mov_b64 exec, -1
    buffer_load_ushort v7, v14, s[36:39], 0 offen
    buffer_load_dword v8, v12, s[56:59], 0 offen sc1
    s_movk_i32 s6, 7168
    buffer_load_dword v9, v12, s[56:59], s6 offen sc1
    s_movk_i32 s6, 14336
    buffer_load_dword v10, v12, s[56:59], s6 offen sc1
    s_movk_i32 s6, 21504
    buffer_load_dword v11, v12, s[56:59], s6 offen sc1
    s_mov_b32 s6, 0
    buffer_load_dwordx4 a[0:3], v86, s[56:59], s6 offen offset:0 sc1
    buffer_load_dwordx4 a[4:7], v86, s[56:59], s6 offen offset:1024 sc1
    buffer_load_dwordx4 a[8:11], v86, s[56:59], s6 offen offset:2048 sc1
    buffer_load_dwordx4 a[12:15], v86, s[56:59], s6 offen offset:3072 sc1
    s_waitcnt vmcnt(9)
    v_mov_b32 v2, 139272
    v_mov_b32 v3, 1
    s_mov_b64 exec, 1
    ds_add_u32 v2, v3
    s_mov_b64 exec, -1
    s_mov_b32 s6, 4096
    buffer_load_dwordx4 a[16:19], v86, s[56:59], s6 offen offset:0 sc1
    buffer_load_dwordx4 a[20:23], v86, s[56:59], s6 offen offset:1024 sc1
    buffer_load_dwordx4 a[24:27], v86, s[56:59], s6 offen offset:2048 sc1
    buffer_load_dwordx4 a[28:31], v86, s[56:59], s6 offen offset:3072 sc1
    s_mov_b32 s6, 8192
    buffer_load_dwordx4 a[32:35], v86, s[56:59], s6 offen offset:0 sc1
    buffer_load_dwordx4 a[36:39], v86, s[56:59], s6 offen offset:1024 sc1
    buffer_load_dwordx4 a[40:43], v86, s[56:59], s6 offen offset:2048 sc1
    buffer_load_dwordx4 a[44:47], v86, s[56:59], s6 offen offset:3072 sc1
    s_mov_b32 s6, 12288
    buffer_load_dwordx4 a[48:51], v86, s[56:59], s6 offen offset:0 sc1
    buffer_load_dwordx4 a[52:55], v86, s[56:59], s6 offen offset:1024 sc1
    buffer_load_dwordx4 a[56:59], v86, s[56:59], s6 offen offset:2048 sc1
    buffer_load_dwordx4 a[60:63], v86, s[56:59], s6 offen offset:3072 sc1
    s_mov_b32 s6, 16384
    buffer_load_dwordx4 a[64:67], v86, s[56:59], s6 offen offset:0 sc1
    buffer_load_dwordx4 a[68:71], v86, s[56:59], s6 offen offset:1024 sc1
    buffer_load_dwordx4 a[72:75], v86, s[56:59], s6 offen offset:2048 sc1
    buffer_load_dwordx4 a[76:79], v86, s[56:59], s6 offen offset:3072 sc1
    s_mov_b32 s6, 20480
    buffer_load_dwordx4 a[80:83], v86, s[56:59], s6 offen offset:0 sc1
    buffer_load_dwordx4 a[84:87], v86, s[56:59], s6 offen offset:1024 sc1
    buffer_load_dwordx4 a[88:91], v86, s[56:59], s6 offen offset:2048 sc1
    buffer_load_dwordx4 a[92:95], v86, s[56:59], s6 offen offset:3072 sc1
    s_mov_b32 s6, 24576
    buffer_load_dwordx4 a[96:99], v86, s[56:59], s6 offen offset:0 sc1
    buffer_load_dwordx4 a[100:103], v86, s[56:59], s6 offen offset:1024 sc1
    buffer_load_dwordx4 a[104:107], v86, s[56:59], s6 offen offset:2048 sc1
    buffer_load_dwordx4 a[108:111], v86, s[56:59], s6 offen offset:3072 sc1
    s_branch A_PRE
HELPER:
    s_load_dwordx2 s[56:57], s[0:1], 104
    s_load_dwordx2 s[40:41], s[0:1], 72
    s_load_dwordx2 s[52:53], s[0:1], 96
    s_mov_b32 s42, 1605632
    s_mov_b32 s43, 0x20000
    s_mov_b32 s58, 268435456
    s_mov_b32 s59, 0x20000
    s_mov_b32 s54, 256
    s_mov_b32 s55, 0x20000
    s_cmp_ge_u32 s2, 252
    s_cbranch_scc1 H_INIT
    s_sub_u32 s7, s2, 224
    v_and_b32 v2, 7, v1
    v_lshrrev_b32 v3, 3, v1
    v_mul_u32_u24 v7, 896, v3
    v_lshl_add_u32 v7, v2, 4, v7
    s_lshr_b32 s4, s7, 2
    s_and_b32 s5, s7, 3
    s_mul_i32 s5, s5, 28
    s_lshl_b32 vcc_lo, s3, 2
    s_add_u32 s5, s5, vcc_lo
    s_mul_i32 vcc_lo, s5, 14336
    s_lshl_b32 vcc_hi, s4, 7
    s_add_u32 vcc_lo, vcc_lo, vcc_hi
    v_add_u32 v7, vcc_lo, v7
    s_mul_i32 s4, s4, 112
    s_add_u32 s4, s4, s5
    s_lshl_b32 s4, s4, 11
    s_add_u32 s4, s4, 7258112
    v_lshl_add_u32 v18, v1, 4, s4
    v_add_u32 v19, 4096, v18
    s_lshl_b32 s6, s3, 13
    v_lshrrev_b32 v2, 4, v1
    v_bfe_u32 v3, v1, 2, 2
    v_and_b32 v4, 3, v1
    v_lshlrev_b32 v23, 7, v3
    v_and_b32 v13, 1, v2
    v_lshl_add_u32 v23, v13, 5, v23
    v_lshl_add_u32 v23, v4, 3, v23
    v_add_u32 v23, s6, v23
    v_lshrrev_b32 v13, 5, v1
    v_lshl_add_u32 v23, v13, 9, v23
    s_mov_b32 m0, s6
    s_mov_b32 s5, 0
    s_mov_b32 s67, 0
    s_and_b32 s4, s2, 1
    s_lshl_b32 s4, s4, 8
    s_add_u32 s4, s4, 3584
    v_mov_b32 v8, s4
    s_waitcnt lgkmcnt(0)
    s_cmp_eq_u32 s3, 0
    s_cbranch_scc0 H_GO
    s_mov_b32 s77, 262144
INIT_16:
    s_cmp_lg_u32 s67, 0
    s_cbranch_scc1 INITOK_17
    v_mov_b32 v2, 0
    buffer_load_dword v3, v2, s[52:55], 0 offen sc1
    s_waitcnt vmcnt(0)
    v_readfirstlane_b32 s67, v3
    s_sub_u32 s77, s77, 1
    s_cbranch_scc0 INIT_16
INITOK_17:
    s_mov_b32 s77, 262144
POLL_18:
    buffer_load_dword v9, v8, s[56:59], 0 offen sc1
    s_waitcnt vmcnt(0)
    v_readfirstlane_b32 s75, v9
    s_cmp_ge_u32 s75, 1
    s_cbranch_scc1 POLLD_19
    s_sub_u32 s77, s77, 1
    s_cbranch_scc0 POLL_18
    v_mov_b32 v9, 88
    v_mov_b32 v8, 4
    buffer_store_dword v9, v8, s[52:55], 0 offen
POLLD_19:
H_GO:
    s_barrier
    buffer_load_dwordx4 v7, s[40:43], s5 offen nt lds
    s_add_u32 m0, m0, 1024
    s_add_u32 s5, s5, 7168
    buffer_load_dwordx4 v7, s[40:43], s5 offen nt lds
    s_add_u32 m0, m0, 1024
    s_add_u32 s5, s5, 7168
    buffer_load_dwordx4 v7, s[40:43], s5 offen nt lds
    s_add_u32 m0, m0, 1024
    s_add_u32 s5, s5, 7168
    buffer_load_dwordx4 v7, s[40:43], s5 offen nt lds
    s_add_u32 m0, m0, 1024
    s_add_u32 s5, s5, 7168
    buffer_load_dwordx4 v7, s[40:43], s5 offen nt lds
    s_add_u32 m0, m0, 1024
    s_add_u32 s5, s5, 7168
    buffer_load_dwordx4 v7, s[40:43], s5 offen nt lds
    s_add_u32 m0, m0, 1024
    s_add_u32 s5, s5, 7168
    buffer_load_dwordx4 v7, s[40:43], s5 offen nt lds
    s_add_u32 m0, m0, 1024
    s_add_u32 s5, s5, 7168
    buffer_load_dwordx4 v7, s[40:43], s5 offen nt lds
    s_waitcnt vmcnt(0)
    ds_read_b64_tr_b16 v[96:97], v23 offset:0
    ds_read_b64_tr_b16 v[98:99], v23 offset:1024
    ds_read_b64_tr_b16 v[100:101], v23 offset:64
    ds_read_b64_tr_b16 v[102:103], v23 offset:1088
    ds_read_b64_tr_b16 v[104:105], v23 offset:2048
    ds_read_b64_tr_b16 v[106:107], v23 offset:3072
    ds_read_b64_tr_b16 v[108:109], v23 offset:2112
    ds_read_b64_tr_b16 v[110:111], v23 offset:3136
    ds_read_b64_tr_b16 v[112:113], v23 offset:4096
    ds_read_b64_tr_b16 v[114:115], v23 offset:5120
    ds_read_b64_tr_b16 v[116:117], v23 offset:4160
    ds_read_b64_tr_b16 v[118:119], v23 offset:5184
    ds_read_b64_tr_b16 v[120:121], v23 offset:6144
    ds_read_b64_tr_b16 v[122:123], v23 offset:7168
    ds_read_b64_tr_b16 v[124:125], v23 offset:6208
    ds_read_b64_tr_b16 v[126:127], v23 offset:7232
    s_waitcnt lgkmcnt(12)
    buffer_store_dwordx4 v[96:99], v18, s[56:59], 0 offen offset:0 sc1
    buffer_store_dwordx4 v[100:103], v18, s[56:59], 0 offen offset:1024 sc1
    s_waitcnt lgkmcnt(8)
    buffer_store_dwordx4 v[104:107], v18, s[56:59], 0 offen offset:2048 sc1
    buffer_store_dwordx4 v[108:111], v18, s[56:59], 0 offen offset:3072 sc1
    s_waitcnt lgkmcnt(4)
    buffer_store_dwordx4 v[112:115], v19, s[56:59], 0 offen offset:0 sc1
    buffer_store_dwordx4 v[116:119], v19, s[56:59], 0 offen offset:1024 sc1
    s_waitcnt lgkmcnt(0)
    buffer_store_dwordx4 v[120:123], v19, s[56:59], 0 offen offset:2048 sc1
    buffer_store_dwordx4 v[124:127], v19, s[56:59], 0 offen offset:3072 sc1
    s_waitcnt vmcnt(0)
    s_barrier
    s_cmp_eq_u32 s3, 0
    s_cbranch_scc0 FINISH
    s_movk_i32 s6, 14336
    s_mov_b32 s75, 1
    s_atomic_add s75, s[56:57], s6 glc
    s_waitcnt lgkmcnt(0)
    s_cmp_lg_u32 s75, 27
    s_cbranch_scc1 ARR_20
    s_mov_b32 s75, 8
    s_atomic_add s75, s[56:57], 26624
    s_atomic_add s75, s[56:57], 26880
    s_atomic_add s75, s[56:57], 27136
    s_atomic_add s75, s[56:57], 27392
    s_atomic_add s75, s[56:57], 27648
    s_atomic_add s75, s[56:57], 27904
    s_atomic_add s75, s[56:57], 28160
    s_atomic_add s75, s[56:57], 28416
    s_waitcnt lgkmcnt(0)
ARR_20:
    s_branch FINISH
H_INIT:
    s_cmp_eq_u32 s2, 252
    s_cselect_b32 s4, s3, 1
    s_cmp_eq_u32 s4, 0
    s_cbranch_scc0 EXIT
    v_lshlrev_b32 v13, 8, v1
    v_mov_b32 v14, 0
    v_mov_b32 v15, 1
    s_movk_i32 s5, 0x4000
    s_waitcnt lgkmcnt(0)
    buffer_store_dword v14, v13, s[56:59], 0 offen sc1
    buffer_store_dword v14, v13, s[56:59], s5 offen sc1
    s_mov_b64 exec, 1
    s_waitcnt vmcnt(0)
    buffer_store_dword v15, v14, s[52:55], 0 offen sc1
    s_endpgm
AUXW:
    s_mul_i32 s4, s7, 8320
    s_add_u32 s4, s4, 32
    v_lshl_add_u32 v9, v1, 4, s4
    s_lshl_b32 s5, s72, 13
    s_lshl_b32 s4, s7, 12
    s_add_u32 s4, s4, s5
    s_add_u32 s5, s4, 65536
    v_lshl_add_u32 v61, v1, 4, s5
    v_lshrrev_b32 v2, 5, v1
    v_bfe_u32 v3, v1, 2, 2
    v_lshl_add_u32 v2, v2, 3, v3
    v_lshlrev_b32 v62, 6, v2
    v_bfe_u32 v3, v1, 4, 1
    v_lshl_add_u32 v62, v3, 5, v62
    v_and_b32 v3, 3, v1
    v_lshl_add_u32 v62, v3, 3, v62
    s_lshl_b32 s4, s7, 12
    s_add_u32 s4, s4, 50432
    v_add_u32 v62, s4, v62
    s_lshl_b32 s4, s25, 10
    s_add_u32 s4, s4, 5652480
    v_lshl_add_u32 v63, v1, 4, s4
    v_add_u32 v58, 4096, v63
    s_and_b32 s4, s72, 3
    s_lshl_b32 s4, s4, 1
    s_add_u32 s4, s4, s7
    s_mul_i32 s4, s4, 7168
    s_lshr_b32 s5, s72, 2
    s_lshl_b32 s5, s5, 7
    s_add_u32 s4, s4, s5
    s_add_u32 s4, s4, 5586944
    v_lshl_add_u32 v59, v1, 2, s4
    v_mov_b32 v56, 0x3f803f80
    v_mov_b32 v57, 0x3f803f80
    s_lshl_b32 s4, s74, 3
    s_add_u32 s4, s4, s60
    s_mul_i32 s5, s4, 28672
    s_add_u32 s5, s5, 5652480
    v_lshl_add_u32 v86, v1, 4, s5
    s_lshl_b32 s4, s4, 6
    v_and_b32 v14, 31, v1
    v_lshl_add_u32 v14, v14, 1, s4
    v_lshrrev_b32 v3, 5, v1
    v_mul_u32_u24 v12, 28672, v3
    v_lshl_add_u32 v12, v14, 1, v12
    v_add_u32 v12, 5586944, v12
    s_mul_i32 s4, s74, 112
    s_mul_i32 s5, s61, 14
    s_add_u32 s4, s4, s5
    s_lshl_b32 s4, s4, 11
    s_add_u32 s4, s4, 7258112
    v_lshl_add_u32 v6, v1, 4, s4
    s_waitcnt vmcnt(0)
    ds_read_b64_tr_b16 v[96:97], v62 offset:0
    ds_read_b64_tr_b16 v[98:99], v62 offset:256
    ds_read_b64_tr_b16 v[100:101], v62 offset:1024
    ds_read_b64_tr_b16 v[102:103], v62 offset:1280
    ds_read_b64_tr_b16 v[104:105], v62 offset:2048
    ds_read_b64_tr_b16 v[106:107], v62 offset:2304
    ds_read_b64_tr_b16 v[108:109], v62 offset:3072
    ds_read_b64_tr_b16 v[110:111], v62 offset:3328
    ds_read_b128 v[16:19], v9 offset:4160
    ds_read_b32 v20, v9 offset:4176
    ds_read_b128 v[24:27], v9 offset:5184
    ds_read_b32 v28, v9 offset:5200
    ds_read_b128 v[32:35], v9 offset:6208
    ds_read_b32 v36, v9 offset:6224
    ds_read_b128 v[40:43], v9 offset:7232
    ds_read_b32 v44, v9 offset:7248
    s_waitcnt lgkmcnt(0)
    s_load_dword s67, s[52:53], 0
    buffer_store_dwordx4 v[96:99], v63, s[56:59], 0 offen offset:0 sc1
    v_mfma_f32_4x4x4_16b_bf16 v[48:51], v[56:57], v[96:97], 0
    v_mfma_f32_4x4x4_16b_bf16 v[52:55], v[56:57], v[98:99], 0
    s_nop 0
    buffer_store_dwordx4 v[100:103], v63, s[56:59], 0 offen offset:2048 sc1
    v_mfma_f32_4x4x4_16b_bf16 v[48:51], v[56:57], v[100:101], v[48:51]
    v_mfma_f32_4x4x4_16b_bf16 v[52:55], v[56:57], v[102:103], v[52:55]
    s_nop 0
    buffer_store_dwordx4 v[104:107], v58, s[56:59], 0 offen offset:0 sc1
    v_mfma_f32_4x4x4_16b_bf16 v[48:51], v[56:57], v[104:105], v[48:51]
    v_mfma_f32_4x4x4_16b_bf16 v[52:55], v[56:57], v[106:107], v[52:55]
    s_nop 0
    s_cmp_eq_u32 s7, 0
    s_cbranch_scc0 K_W1ST
    buffer_store_dwordx4 v[108:111], v58, s[56:59], 0 offen offset:2048 sc1
    v_mfma_f32_4x4x4_16b_bf16 v[48:51], v[56:57], v[108:109], v[48:51]
    v_mfma_f32_4x4x4_16b_bf16 v[52:55], v[56:57], v[110:111], v[52:55]
    s_nop 0
K_W1ST:
    v_alignbit_b32 v64, v17, v16, 16
    v_alignbit_b32 v65, v18, v17, 16
    v_alignbit_b32 v66, v19, v18, 16
    v_alignbit_b32 v67, v20, v19, 16
    ds_write_b128 v9, v[64:67] offset:0
    v_alignbit_b32 v68, v25, v24, 16
    v_alignbit_b32 v69, v26, v25, 16
    v_alignbit_b32 v70, v27, v26, 16
    v_alignbit_b32 v71, v28, v27, 16
    ds_write_b128 v9, v[68:71] offset:1024
    v_alignbit_b32 v72, v33, v32, 16
    v_alignbit_b32 v73, v34, v33, 16
    v_alignbit_b32 v74, v35, v34, 16
    v_alignbit_b32 v75, v36, v35, 16
    ds_write_b128 v9, v[72:75] offset:2048
    v_alignbit_b32 v76, v41, v40, 16
    v_alignbit_b32 v77, v42, v41, 16
    v_alignbit_b32 v78, v43, v42, 16
    v_alignbit_b32 v79, v44, v43, 16
    ds_write_b128 v9, v[76:79] offset:3072
    v_lshlrev_b32 v13, 16, v16
    v_subrev_u32 v2, 4, v9
    s_mov_b64 exec, 1
    ds_write_b32 v2, v13
    s_mov_b64 exec, -1
    v_add_f32 v48, v48, v52
    v_mov_b32 v49, v48
    s_and_b32 s6, s2, 7
    s_lshl_b32 s6, s6, 8
    s_add_u32 s6, s6, 6144
    v_permlane32_swap_b32 v48, v49
    v_add_f32 v48, v48, v49
    s_mov_b32 exec_hi, 0
    buffer_store_dword v48, v59, s[56:59], 0 offen sc1
    s_mov_b32 exec_hi, -1
    s_waitcnt vmcnt(0) lgkmcnt(0)
    s_mov_b32 s77, 262144
INIT_21:
    s_cmp_lg_u32 s67, 0
    s_cbranch_scc1 INITOK_22
    v_mov_b32 v2, 0
    buffer_load_dword v3, v2, s[52:55], 0 offen sc1
    s_waitcnt vmcnt(0)
    v_readfirstlane_b32 s67, v3
    s_sub_u32 s77, s77, 1
    s_cbranch_scc0 INIT_21
INITOK_22:
    v_mov_b32 v2, 139268
    v_mov_b32 v3, 1
    s_mov_b64 exec, 1
    ds_add_rtn_u32 v3, v2, v3
    s_waitcnt lgkmcnt(0)
    s_mov_b64 exec, -1
    v_readfirstlane_b32 s75, v3
    s_cmp_lg_u32 s75, 3
    s_cbranch_scc1 K_SB_DONE
    s_mov_b32 s75, 1
    s_atomic_add s75, s[56:57], s6 glc
    s_waitcnt lgkmcnt(0)
    s_cmp_lg_u32 s75, 27
    s_cbranch_scc1 ARR_23
    s_mov_b32 s75, 1
    s_atomic_add s75, s[56:57], 8192
    s_atomic_add s75, s[56:57], 8448
    s_atomic_add s75, s[56:57], 8704
    s_atomic_add s75, s[56:57], 8960
    s_atomic_add s75, s[56:57], 9216
    s_atomic_add s75, s[56:57], 9472
    s_atomic_add s75, s[56:57], 9728
    s_atomic_add s75, s[56:57], 9984
    s_waitcnt lgkmcnt(0)
ARR_23:
K_SB_DONE:
    v_mov_b32 v2, 139292
    s_waitcnt vmcnt(0)
    s_barrier
    s_mov_b32 s77, 262144
SPIN_24:
    ds_read_b32 v3, v2
    s_waitcnt lgkmcnt(0)
    v_readfirstlane_b32 s75, v3
    s_cmp_ge_u32 s75, 2
    s_cbranch_scc1 SPINOK_25
    s_sub_u32 s77, s77, 1
    s_cbranch_scc0 SPIN_24
SPINOK_25:
    buffer_load_ushort v7, v14, s[36:39], 0 offen
    buffer_load_dword v8, v12, s[56:59], 0 offen sc1
    s_movk_i32 s6, 7168
    buffer_load_dword v9, v12, s[56:59], s6 offen sc1
    s_movk_i32 s6, 14336
    buffer_load_dword v10, v12, s[56:59], s6 offen sc1
    s_movk_i32 s6, 21504
    buffer_load_dword v11, v12, s[56:59], s6 offen sc1
    s_mov_b32 s6, 0
    buffer_load_dwordx4 a[0:3], v86, s[56:59], s6 offen offset:0 sc1
    buffer_load_dwordx4 a[4:7], v86, s[56:59], s6 offen offset:1024 sc1
    buffer_load_dwordx4 a[8:11], v86, s[56:59], s6 offen offset:2048 sc1
    buffer_load_dwordx4 a[12:15], v86, s[56:59], s6 offen offset:3072 sc1
    s_mov_b32 s6, 4096
    buffer_load_dwordx4 a[16:19], v86, s[56:59], s6 offen offset:0 sc1
    buffer_load_dwordx4 a[20:23], v86, s[56:59], s6 offen offset:1024 sc1
    buffer_load_dwordx4 a[24:27], v86, s[56:59], s6 offen offset:2048 sc1
    buffer_load_dwordx4 a[28:31], v86, s[56:59], s6 offen offset:3072 sc1
    s_mov_b32 s6, 8192
    buffer_load_dwordx4 a[32:35], v86, s[56:59], s6 offen offset:0 sc1
    buffer_load_dwordx4 a[36:39], v86, s[56:59], s6 offen offset:1024 sc1
    buffer_load_dwordx4 a[40:43], v86, s[56:59], s6 offen offset:2048 sc1
    buffer_load_dwordx4 a[44:47], v86, s[56:59], s6 offen offset:3072 sc1
    s_mov_b32 s6, 12288
    buffer_load_dwordx4 a[48:51], v86, s[56:59], s6 offen offset:0 sc1
    buffer_load_dwordx4 a[52:55], v86, s[56:59], s6 offen offset:1024 sc1
    buffer_load_dwordx4 a[56:59], v86, s[56:59], s6 offen offset:2048 sc1
    buffer_load_dwordx4 a[60:63], v86, s[56:59], s6 offen offset:3072 sc1
    s_mov_b32 s6, 16384
    buffer_load_dwordx4 a[64:67], v86, s[56:59], s6 offen offset:0 sc1
    buffer_load_dwordx4 a[68:71], v86, s[56:59], s6 offen offset:1024 sc1
    buffer_load_dwordx4 a[72:75], v86, s[56:59], s6 offen offset:2048 sc1
    buffer_load_dwordx4 a[76:79], v86, s[56:59], s6 offen offset:3072 sc1
    s_mov_b32 s6, 20480
    buffer_load_dwordx4 a[80:83], v86, s[56:59], s6 offen offset:0 sc1
    buffer_load_dwordx4 a[84:87], v86, s[56:59], s6 offen offset:1024 sc1
    buffer_load_dwordx4 a[88:91], v86, s[56:59], s6 offen offset:2048 sc1
    buffer_load_dwordx4 a[92:95], v86, s[56:59], s6 offen offset:3072 sc1
    s_mov_b32 s6, 24576
    buffer_load_dwordx4 a[96:99], v86, s[56:59], s6 offen offset:0 sc1
    buffer_load_dwordx4 a[100:103], v86, s[56:59], s6 offen offset:1024 sc1
    buffer_load_dwordx4 a[104:107], v86, s[56:59], s6 offen offset:2048 sc1
    buffer_load_dwordx4 a[108:111], v86, s[56:59], s6 offen offset:3072 sc1
A_PRE:
    s_waitcnt vmcnt(28)
    v_lshrrev_b32 v2, 5, v1
    v_bfe_u32 v3, v1, 2, 2
    v_lshl_add_u32 v2, v2, 3, v3
    v_lshlrev_b32 v2, 7, v2
    v_lshrrev_b32 v3, 1, v3
    v_lshl_add_u32 v2, v3, 6, v2
    v_bfe_u32 v3, v1, 4, 1
    v_lshl_add_u32 v2, v3, 5, v2
    v_and_b32 v3, 3, v1
    v_lshl_add_u32 v2, v3, 3, v2
    v_add_u32 v2, 65536, v2
    v_xor_b32 v3, 64, v2
    s_mul_i32 s4, s73, 112
    s_lshl_b32 s5, s74, 4
    s_add_u32 s4, s4, s5
    s_lshl_b32 s5, s60, 1
    s_add_u32 s4, s4, s5
    s_lshl_b32 s4, s4, 11
    s_add_u32 s4, s4, 8863744
    v_lshl_add_u32 v4, v1, 4, s4
    v_lshrrev_b32 v5, 3, v1
    v_lshlrev_b32 v5, 12, v5
    v_and_b32 v15, 7, v1
    v_bfe_u32 v16, v1, 4, 1
    v_lshlrev_b32 v16, 2, v16
    v_xor_b32 v15, v15, v16
    v_lshl_add_u32 v5, v15, 4, v5
    s_and_b32 s7, s3, 3
    s_lshl_b32 s4, s7, 16
    s_lshl_b32 s5, s73, 7
    s_add_u32 s4, s4, s5
    s_add_u32 s4, s4, 3735552
    v_add_u32 v5, s4, v5
    v_cmp_gt_u32 vcc, 32, v1
    v_add_f32 v8, v8, v9
    v_add_f32 v10, v10, v11
    v_add_f32 v8, v8, v10
    v_mov_b32 v9, v8
    s_nop 1
    v_permlane32_swap_b32 v8, v9
    v_add_f32 v8, v8, v9
    v_cvt_pk_bf16_f32 v9, v8, v8
    v_lshlrev_b32 v9, 16, v9
    v_sub_f32 v9, v8, v9
    v_cvt_pk_bf16_f32 v56, v8, v9
    v_and_b32 v57, 0xffff, v56
    v_lshl_or_b32 v57, v7, 16, v57
    v_mov_b32 v59, 0
    v_mov_b32 v63, 0
    v_cndmask_b32 v56, 0, v56, vcc
    v_cndmask_b32 v57, 0, v57, vcc
    v_cndmask_b32 v58, 0, v7, vcc
    v_mov_b32 v67, 0
    s_cmp_ge_u32 s3, 6
    s_cbranch_scc0 S2_WAIT
    s_and_b32 s6, s2, 7
    s_lshl_b32 s6, s6, 8
    s_add_u32 s6, s6, 12288
    s_cmp_eq_u32 s3, 7
    s_cselect_b32 s5, 14336, 0
    s_add_u32 s6, s6, s5
    v_mov_b32 v8, s6
    s_mov_b32 s77, 262144
POLL_26:
    buffer_load_dword v9, v8, s[56:59], 0 offen sc1
    s_waitcnt vmcnt(0)
    v_readfirstlane_b32 s75, v9
    s_cmp_ge_u32 s75, 8
    s_cbranch_scc1 POLLD_27
    s_sub_u32 s77, s77, 1
    s_cbranch_scc0 POLL_26
    v_mov_b32 v9, 82
    v_mov_b32 v8, 4
    buffer_store_dword v9, v8, s[52:55], 0 offen
POLLD_27:
S2_WAIT:
    s_lshl_b32 s4, s7, 11
    s_add_u32 s4, s4, 65536
    s_mov_b32 s5, 0
    s_mov_b32 m0, s4
    s_barrier
    buffer_load_dwordx4 v5, s[56:59], s5 offen sc1 lds
    s_add_u32 s4, s4, 1024
    s_add_u32 s5, s5, 32768
    s_mov_b32 m0, s4
    s_nop 0
    buffer_load_dwordx4 v5, s[56:59], s5 offen sc1 lds
    s_add_u32 s4, s4, 7168
    s_add_u32 s5, s5, 229376
    s_mov_b32 m0, s4
    s_nop 0
    buffer_load_dwordx4 v5, s[56:59], s5 offen sc1 lds
    s_add_u32 s4, s4, 1024
    s_add_u32 s5, s5, 32768
    s_mov_b32 m0, s4
    s_nop 0
    buffer_load_dwordx4 v5, s[56:59], s5 offen sc1 lds
    s_add_u32 s4, s4, 7168
    s_add_u32 s5, s5, 229376
    s_mov_b32 m0, s4
    s_nop 0
    buffer_load_dwordx4 v5, s[56:59], s5 offen sc1 lds
    s_add_u32 s4, s4, 1024
    s_add_u32 s5, s5, 32768
    s_mov_b32 m0, s4
    s_nop 0
    buffer_load_dwordx4 v5, s[56:59], s5 offen sc1 lds
    s_add_u32 s4, s4, 7168
    s_add_u32 s5, s5, 229376
    s_mov_b32 m0, s4
    s_nop 0
    buffer_load_dwordx4 v5, s[56:59], s5 offen sc1 lds
    s_add_u32 s4, s4, 1024
    s_add_u32 s5, s5, 32768
    s_mov_b32 m0, s4
    s_nop 0
    buffer_load_dwordx4 v5, s[56:59], s5 offen sc1 lds
    s_add_u32 s4, s4, 7168
    s_add_u32 s5, s5, 229376
    s_mov_b32 m0, s4
    s_nop 0
    buffer_load_dwordx4 v5, s[56:59], s5 offen sc1 lds
    s_add_u32 s4, s4, 1024
    s_add_u32 s5, s5, 32768
    s_mov_b32 m0, s4
    s_nop 0
    buffer_load_dwordx4 v5, s[56:59], s5 offen sc1 lds
    s_add_u32 s4, s4, 7168
    s_add_u32 s5, s5, 229376
    s_mov_b32 m0, s4
    s_nop 0
    buffer_load_dwordx4 v5, s[56:59], s5 offen sc1 lds
    s_add_u32 s4, s4, 1024
    s_add_u32 s5, s5, 32768
    s_mov_b32 m0, s4
    s_nop 0
    buffer_load_dwordx4 v5, s[56:59], s5 offen sc1 lds
    s_add_u32 s4, s4, 7168
    s_add_u32 s5, s5, 229376
    s_mov_b32 m0, s4
    s_nop 0
    buffer_load_dwordx4 v5, s[56:59], s5 offen sc1 lds
    s_add_u32 s4, s4, 1024
    s_add_u32 s5, s5, 32768
    s_mov_b32 m0, s4
    s_nop 0
    buffer_load_dwordx4 v5, s[56:59], s5 offen sc1 lds
    s_waitcnt vmcnt(12)
    s_barrier
    ds_read_b64_tr_b16 v[24:25], v2 offset:0
    ds_read_b64_tr_b16 v[26:27], v2 offset:512
    ds_read_b64_tr_b16 v[28:29], v2 offset:2048
    ds_read_b64_tr_b16 v[30:31], v2 offset:2560
    ds_read_b64_tr_b16 v[32:33], v2 offset:4096
    ds_read_b64_tr_b16 v[34:35], v2 offset:4608
    ds_read_b64_tr_b16 v[36:37], v2 offset:6144
    ds_read_b64_tr_b16 v[38:39], v2 offset:6656
    s_waitcnt vmcnt(10)
    s_barrier
    ds_read_b64_tr_b16 v[40:41], v2 offset:8192
    ds_read_b64_tr_b16 v[42:43], v2 offset:8704
    ds_read_b64_tr_b16 v[44:45], v2 offset:10240
    ds_read_b64_tr_b16 v[46:47], v2 offset:10752
    ds_read_b64_tr_b16 v[48:49], v2 offset:12288
    ds_read_b64_tr_b16 v[50:51], v2 offset:12800
    ds_read_b64_tr_b16 v[52:53], v2 offset:14336
    ds_read_b64_tr_b16 v[54:55], v2 offset:14848
    s_waitcnt lgkmcnt(8)
    v_mfma_f32_32x32x16_bf16 v[8:23], a[0:3], v[24:27], 0
    v_mfma_f32_32x32x16_bf16 v[8:23], a[4:7], v[28:31], v[8:23]
    v_mfma_f32_32x32x16_bf16 v[8:23], a[8:11], v[32:35], v[8:23]
    v_mfma_f32_32x32x16_bf16 v[8:23], a[12:15], v[36:39], v[8:23]
    s_waitcnt vmcnt(8)
    s_barrier
    ds_read_b64_tr_b16 v[24:25], v2 offset:16384
    ds_read_b64_tr_b16 v[26:27], v2 offset:16896
    ds_read_b64_tr_b16 v[28:29], v2 offset:18432
    ds_read_b64_tr_b16 v[30:31], v2 offset:18944
    ds_read_b64_tr_b16 v[32:33], v2 offset:20480
    ds_read_b64_tr_b16 v[34:35], v2 offset:20992
    ds_read_b64_tr_b16 v[36:37], v2 offset:22528
    ds_read_b64_tr_b16 v[38:39], v2 offset:23040
    s_waitcnt lgkmcnt(8)
    v_mfma_f32_32x32x16_bf16 v[8:23], a[16:19], v[40:43], v[8:23]
    v_mfma_f32_32x32x16_bf16 v[8:23], a[20:23], v[44:47], v[8:23]
    v_mfma_f32_32x32x16_bf16 v[8:23], a[24:27], v[48:51], v[8:23]
    v_mfma_f32_32x32x16_bf16 v[8:23], a[28:31], v[52:55], v[8:23]
    s_waitcnt vmcnt(6)
    s_barrier
    ds_read_b64_tr_b16 v[40:41], v2 offset:24576
    ds_read_b64_tr_b16 v[42:43], v2 offset:25088
    ds_read_b64_tr_b16 v[44:45], v2 offset:26624
    ds_read_b64_tr_b16 v[46:47], v2 offset:27136
    ds_read_b64_tr_b16 v[48:49], v2 offset:28672
    ds_read_b64_tr_b16 v[50:51], v2 offset:29184
    ds_read_b64_tr_b16 v[52:53], v2 offset:30720
    ds_read_b64_tr_b16 v[54:55], v2 offset:31232
    s_waitcnt lgkmcnt(8)
    v_mfma_f32_32x32x16_bf16 v[8:23], a[32:35], v[24:27], v[8:23]
    v_mfma_f32_32x32x16_bf16 v[8:23], a[36:39], v[28:31], v[8:23]
    v_mfma_f32_32x32x16_bf16 v[8:23], a[40:43], v[32:35], v[8:23]
    v_mfma_f32_32x32x16_bf16 v[8:23], a[44:47], v[36:39], v[8:23]
    s_waitcnt vmcnt(4)
    s_barrier
    ds_read_b64_tr_b16 v[24:25], v2 offset:32768
    ds_read_b64_tr_b16 v[26:27], v2 offset:33280
    ds_read_b64_tr_b16 v[28:29], v2 offset:34816
    ds_read_b64_tr_b16 v[30:31], v2 offset:35328
    ds_read_b64_tr_b16 v[32:33], v2 offset:36864
    ds_read_b64_tr_b16 v[34:35], v2 offset:37376
    ds_read_b64_tr_b16 v[36:37], v2 offset:38912
    ds_read_b64_tr_b16 v[38:39], v2 offset:39424
    s_waitcnt lgkmcnt(8)
    v_mfma_f32_32x32x16_bf16 v[8:23], a[48:51], v[40:43], v[8:23]
    v_mfma_f32_32x32x16_bf16 v[8:23], a[52:55], v[44:47], v[8:23]
    v_mfma_f32_32x32x16_bf16 v[8:23], a[56:59], v[48:51], v[8:23]
    v_mfma_f32_32x32x16_bf16 v[8:23], a[60:63], v[52:55], v[8:23]
    s_waitcnt vmcnt(2)
    s_barrier
    ds_read_b64_tr_b16 v[40:41], v2 offset:40960
    ds_read_b64_tr_b16 v[42:43], v2 offset:41472
    ds_read_b64_tr_b16 v[44:45], v2 offset:43008
    ds_read_b64_tr_b16 v[46:47], v2 offset:43520
    ds_read_b64_tr_b16 v[48:49], v2 offset:45056
    ds_read_b64_tr_b16 v[50:51], v2 offset:45568
    ds_read_b64_tr_b16 v[52:53], v2 offset:47104
    ds_read_b64_tr_b16 v[54:55], v2 offset:47616
    s_waitcnt lgkmcnt(8)
    v_mfma_f32_32x32x16_bf16 v[8:23], a[64:67], v[24:27], v[8:23]
    v_mfma_f32_32x32x16_bf16 v[8:23], a[68:71], v[28:31], v[8:23]
    v_mfma_f32_32x32x16_bf16 v[8:23], a[72:75], v[32:35], v[8:23]
    v_mfma_f32_32x32x16_bf16 v[8:23], a[76:79], v[36:39], v[8:23]
    s_waitcnt vmcnt(0)
    s_barrier
    ds_read_b64_tr_b16 v[24:25], v2 offset:49152
    ds_read_b64_tr_b16 v[26:27], v2 offset:49664
    ds_read_b64_tr_b16 v[28:29], v2 offset:51200
    ds_read_b64_tr_b16 v[30:31], v2 offset:51712
    ds_read_b64_tr_b16 v[32:33], v2 offset:53248
    ds_read_b64_tr_b16 v[34:35], v2 offset:53760
    ds_read_b64_tr_b16 v[36:37], v2 offset:55296
    ds_read_b64_tr_b16 v[38:39], v2 offset:55808
    s_waitcnt lgkmcnt(8)
    v_mfma_f32_32x32x16_bf16 v[8:23], a[80:83], v[40:43], v[8:23]
    v_mfma_f32_32x32x16_bf16 v[8:23], a[84:87], v[44:47], v[8:23]
    v_mfma_f32_32x32x16_bf16 v[8:23], a[88:91], v[48:51], v[8:23]
    v_mfma_f32_32x32x16_bf16 v[8:23], a[92:95], v[52:55], v[8:23]
    v_and_b32 v76, 31, v1
    s_lshl_b32 s4, s74, 7
    v_lshl_add_u32 v76, v76, 1, s4
    s_waitcnt lgkmcnt(0)
    v_mfma_f32_32x32x16_bf16 v[8:23], a[96:99], v[24:27], v[8:23]
    v_mfma_f32_32x32x16_bf16 v[8:23], a[100:103], v[28:31], v[8:23]
    v_mfma_f32_32x32x16_bf16 v[8:23], a[104:107], v[32:35], v[8:23]
    v_mfma_f32_32x32x16_bf16 v[8:23], a[108:111], v[36:39], v[8:23]
    buffer_load_ushort v5, v76, s[44:47], 0 offen
    buffer_load_ushort v7, v76, s[44:47], 0 offen offset:64
    s_barrier
    s_setprio 1
    v_lshlrev_b32 v76, 3, v1
    v_add_u32 v76, 139328, v76
    ds_read_b64 v[78:79], v76 offset:0
    ds_read_b64 v[80:81], v76 offset:512
    ds_read_b64 v[82:83], v76 offset:1024
    ds_read_b64 v[84:85], v76 offset:1536
    s_waitcnt lgkmcnt(2)
    v_add_f32 v78, v78, v80
    v_add_f32 v79, v79, v81
    s_waitcnt lgkmcnt(0)
    v_add_f32 v82, v82, v84
    v_add_f32 v83, v83, v85
    v_add_f32 v78, v78, v82
    v_add_f32 v79, v79, v83
    v_mul_f32 v78, 0xbb124925, v78
    v_mul_f32 v79, 0x3b124925, v79
    v_fma_f32 v79, -v78, v78, v79
    v_max_f32 v79, 0, v79
    v_add_f32 v80, 0x3727c5ac, v79
    v_rsq_f32 v80, v80
    v_cvt_pk_bf16_f32 v60, v78, v78
    v_mul_f32 v79, v79, v80
    v_mul_f32 v79, v79, v80
    v_add_f32 v79, 0x3727c5ac, v79
    v_rsq_f32 v79, v79
    v_lshlrev_b32 v81, 16, v60
    v_mul_f32 v79, v79, v80
    v_rcp_f32 v72, v79
    v_sub_f32 v81, v78, v81
    v_mul_f32 v68, 0xc0135761, v79
    v_mul_f32 v80, v79, v79
    v_mul_f32 v80, 0x3d372713, v80
    v_mul_f32 v70, v68, v80
    v_cvt_pk_bf16_f32 v61, v81, v72
    v_and_b32 v80, s76, v61
    v_sub_f32 v80, v72, v80
    v_cvt_pk_bf16_f32 v62, v80, 0
    v_mov_b32 v69, v68
    v_mov_b32 v71, v70
    v_mov_b32 v73, v72
    v_mov_b32 v64, v60
    v_mov_b32 v65, v61
    v_mov_b32 v66, v62
    s_nop 1
    v_permlane32_swap_b32 v68, v69
    v_permlane32_swap_b32 v70, v71
    v_permlane32_swap_b32 v72, v73
    v_permlane32_swap_b32 v60, v64
    v_permlane32_swap_b32 v61, v65
    v_permlane32_swap_b32 v62, v66
    s_nop 1
    v_mfma_f32_32x32x16_bf16 v[8:23], v[56:59], v[60:63], v[8:23]
    s_nop 11
    v_mul_f32 v24, v8, v8
    v_mul_f32 v25, v9, v9
    v_mul_f32 v26, v10, v10
    v_mul_f32 v27, v11, v11
    v_fma_f32 v24, v24, v70, v68
    v_fma_f32 v25, v25, v70, v68
    v_fma_f32 v26, v26, v70, v68
    v_fma_f32 v27, v27, v70, v68
    v_mul_f32 v24, v24, v8
    v_mul_f32 v25, v25, v9
    v_mul_f32 v26, v26, v10
    v_mul_f32 v27, v27, v11
    v_exp_f32 v24, v24
    v_exp_f32 v25, v25
    v_exp_f32 v26, v26
    v_exp_f32 v27, v27
    s_mov_b32 s6, 0
    buffer_load_dwordx4 a[112:115], v6, s[56:59], s6 offen offset:0 sc1
    v_fma_f32 v24, v24, v72, v72
    v_fma_f32 v25, v25, v72, v72
    v_fma_f32 v26, v26, v72, v72
    v_fma_f32 v27, v27, v72, v72
    v_rcp_f32 v24, v24
    v_rcp_f32 v25, v25
    v_rcp_f32 v26, v26
    v_rcp_f32 v27, v27
    buffer_load_dwordx4 a[116:119], v6, s[56:59], s6 offen offset:1024 sc1
    v_mul_f32 v24, v24, v8
    v_mul_f32 v25, v25, v9
    v_mul_f32 v26, v26, v10
    v_mul_f32 v27, v27, v11
    v_cvt_pk_bf16_f32 v40, v24, v25
    v_cvt_pk_bf16_f32 v41, v26, v27
    v_mul_f32 v28, v12, v12
    v_mul_f32 v29, v13, v13
    v_mul_f32 v30, v14, v14
    v_mul_f32 v31, v15, v15
    v_fma_f32 v28, v28, v70, v68
    v_fma_f32 v29, v29, v70, v68
    v_fma_f32 v30, v30, v70, v68
    v_fma_f32 v31, v31, v70, v68
    v_mul_f32 v28, v28, v12
    v_mul_f32 v29, v29, v13
    v_mul_f32 v30, v30, v14
    v_mul_f32 v31, v31, v15
    v_exp_f32 v28, v28
    v_exp_f32 v29, v29
    v_exp_f32 v30, v30
    v_exp_f32 v31, v31
    buffer_load_dwordx4 a[120:123], v6, s[56:59], s6 offen offset:2048 sc1
    v_fma_f32 v28, v28, v72, v72
    v_fma_f32 v29, v29, v72, v72
    v_fma_f32 v30, v30, v72, v72
    v_fma_f32 v31, v31, v72, v72
    v_rcp_f32 v28, v28
    v_rcp_f32 v29, v29
    v_rcp_f32 v30, v30
    v_rcp_f32 v31, v31
    buffer_load_dwordx4 a[124:127], v6, s[56:59], s6 offen offset:3072 sc1
    v_mul_f32 v28, v28, v12
    v_mul_f32 v29, v29, v13
    v_mul_f32 v30, v30, v14
    v_mul_f32 v31, v31, v15
    v_cvt_pk_bf16_f32 v42, v28, v29
    v_cvt_pk_bf16_f32 v43, v30, v31
    buffer_store_dwordx4 v[40:43], v4, s[56:59], 0 offen offset:0 sc1
    v_mul_f32 v24, v16, v16
    v_mul_f32 v25, v17, v17
    v_mul_f32 v26, v18, v18
    v_mul_f32 v27, v19, v19
    v_fma_f32 v24, v24, v70, v68
    v_fma_f32 v25, v25, v70, v68
    v_fma_f32 v26, v26, v70, v68
    v_fma_f32 v27, v27, v70, v68
    v_mul_f32 v24, v24, v16
    v_mul_f32 v25, v25, v17
    v_mul_f32 v26, v26, v18
    v_mul_f32 v27, v27, v19
    v_exp_f32 v24, v24
    v_exp_f32 v25, v25
    v_exp_f32 v26, v26
    v_exp_f32 v27, v27
    s_mov_b32 s6, 4096
    buffer_load_dwordx4 v[88:91], v6, s[56:59], s6 offen offset:0 sc1
    v_fma_f32 v24, v24, v72, v72
    v_fma_f32 v25, v25, v72, v72
    v_fma_f32 v26, v26, v72, v72
    v_fma_f32 v27, v27, v72, v72
    v_rcp_f32 v24, v24
    v_rcp_f32 v25, v25
    v_rcp_f32 v26, v26
    v_rcp_f32 v27, v27
    buffer_load_dwordx4 v[92:95], v6, s[56:59], s6 offen offset:1024 sc1
    v_mul_f32 v24, v24, v16
    v_mul_f32 v25, v25, v17
    v_mul_f32 v26, v26, v18
    v_mul_f32 v27, v27, v19
    v_cvt_pk_bf16_f32 v44, v24, v25
    v_cvt_pk_bf16_f32 v45, v26, v27
    v_mul_f32 v28, v20, v20
    v_mul_f32 v29, v21, v21
    v_mul_f32 v30, v22, v22
    v_mul_f32 v31, v23, v23
    v_fma_f32 v28, v28, v70, v68
    v_fma_f32 v29, v29, v70, v68
    v_fma_f32 v30, v30, v70, v68
    v_fma_f32 v31, v31, v70, v68
    v_mul_f32 v28, v28, v20
    v_mul_f32 v29, v29, v21
    v_mul_f32 v30, v30, v22
    v_mul_f32 v31, v31, v23
    v_exp_f32 v28, v28
    v_exp_f32 v29, v29
    v_exp_f32 v30, v30
    v_exp_f32 v31, v31
    buffer_load_dwordx4 v[96:99], v6, s[56:59], s6 offen offset:2048 sc1
    v_fma_f32 v28, v28, v72, v72
    v_fma_f32 v29, v29, v72, v72
    v_fma_f32 v30, v30, v72, v72
    v_fma_f32 v31, v31, v72, v72
    v_rcp_f32 v28, v28
    v_rcp_f32 v29, v29
    v_rcp_f32 v30, v30
    v_rcp_f32 v31, v31
    v_mul_f32 v28, v28, v20
    v_mul_f32 v29, v29, v21
    v_mul_f32 v30, v30, v22
    v_mul_f32 v31, v31, v23
    v_cvt_pk_bf16_f32 v46, v28, v29
    v_cvt_pk_bf16_f32 v47, v30, v31
    buffer_store_dwordx4 v[44:47], v4, s[56:59], 0 offen offset:2048 sc1
    s_setprio 3
    ds_read_b64_tr_b16 v[24:25], v3 offset:0
    ds_read_b64_tr_b16 v[26:27], v3 offset:512
    ds_read_b64_tr_b16 v[28:29], v3 offset:2048
    ds_read_b64_tr_b16 v[30:31], v3 offset:2560
    ds_read_b64_tr_b16 v[32:33], v3 offset:4096
    ds_read_b64_tr_b16 v[34:35], v3 offset:4608
    ds_read_b64_tr_b16 v[36:37], v3 offset:6144
    ds_read_b64_tr_b16 v[38:39], v3 offset:6656
    ds_read_b64_tr_b16 v[40:41], v3 offset:8192
    ds_read_b64_tr_b16 v[42:43], v3 offset:8704
    s_waitcnt lgkmcnt(8)
    v_mfma_f32_32x32x16_bf16 v[8:23], a[0:3], v[24:27], 0
    ds_read_b64_tr_b16 v[44:45], v3 offset:10240
    ds_read_b64_tr_b16 v[46:47], v3 offset:10752
    s_waitcnt lgkmcnt(8)
    v_mfma_f32_32x32x16_bf16 v[8:23], a[4:7], v[28:31], v[8:23]
    s_movk_i32 s6, 4096
    buffer_load_dwordx4 v[100:103], v6, s[56:59], s6 offen offset:3072 sc1
    ds_read_b64_tr_b16 v[48:49], v3 offset:12288
    ds_read_b64_tr_b16 v[50:51], v3 offset:12800
    s_waitcnt lgkmcnt(8)
    v_mfma_f32_32x32x16_bf16 v[8:23], a[8:11], v[32:35], v[8:23]
    ds_read_b64_tr_b16 v[52:53], v3 offset:14336
    ds_read_b64_tr_b16 v[54:55], v3 offset:14848
    s_waitcnt lgkmcnt(8)
    v_mfma_f32_32x32x16_bf16 v[8:23], a[12:15], v[36:39], v[8:23]
    ds_read_b64_tr_b16 v[24:25], v3 offset:16384
    ds_read_b64_tr_b16 v[26:27], v3 offset:16896
    s_waitcnt lgkmcnt(8)
    v_mfma_f32_32x32x16_bf16 v[8:23], a[16:19], v[40:43], v[8:23]
    ds_read_b64_tr_b16 v[28:29], v3 offset:18432
    ds_read_b64_tr_b16 v[30:31], v3 offset:18944
    s_waitcnt lgkmcnt(8)
    v_mfma_f32_32x32x16_bf16 v[8:23], a[20:23], v[44:47], v[8:23]
    s_mov_b32 s6, 8192
    buffer_load_dwordx4 v[104:107], v6, s[56:59], s6 offen offset:0 sc1
    ds_read_b64_tr_b16 v[32:33], v3 offset:20480
    ds_read_b64_tr_b16 v[34:35], v3 offset:20992
    s_waitcnt lgkmcnt(8)
    v_mfma_f32_32x32x16_bf16 v[8:23], a[24:27], v[48:51], v[8:23]
    ds_read_b64_tr_b16 v[36:37], v3 offset:22528
    ds_read_b64_tr_b16 v[38:39], v3 offset:23040
    s_waitcnt lgkmcnt(8)
    v_mfma_f32_32x32x16_bf16 v[8:23], a[28:31], v[52:55], v[8:23]
    ds_read_b64_tr_b16 v[40:41], v3 offset:24576
    ds_read_b64_tr_b16 v[42:43], v3 offset:25088
    s_waitcnt lgkmcnt(8)
    v_mfma_f32_32x32x16_bf16 v[8:23], a[32:35], v[24:27], v[8:23]
    ds_read_b64_tr_b16 v[44:45], v3 offset:26624
    ds_read_b64_tr_b16 v[46:47], v3 offset:27136
    s_waitcnt lgkmcnt(8)
    v_mfma_f32_32x32x16_bf16 v[8:23], a[36:39], v[28:31], v[8:23]
    buffer_load_dwordx4 v[108:111], v6, s[56:59], s6 offen offset:1024 sc1
    ds_read_b64_tr_b16 v[48:49], v3 offset:28672
    ds_read_b64_tr_b16 v[50:51], v3 offset:29184
    s_waitcnt lgkmcnt(8)
    v_mfma_f32_32x32x16_bf16 v[8:23], a[40:43], v[32:35], v[8:23]
    ds_read_b64_tr_b16 v[52:53], v3 offset:30720
    ds_read_b64_tr_b16 v[54:55], v3 offset:31232
    s_waitcnt lgkmcnt(8)
    v_mfma_f32_32x32x16_bf16 v[8:23], a[44:47], v[36:39], v[8:23]
    ds_read_b64_tr_b16 v[24:25], v3 offset:32768
    ds_read_b64_tr_b16 v[26:27], v3 offset:33280
    s_waitcnt lgkmcnt(8)
    v_mfma_f32_32x32x16_bf16 v[8:23], a[48:51], v[40:43], v[8:23]
    ds_read_b64_tr_b16 v[28:29], v3 offset:34816
    ds_read_b64_tr_b16 v[30:31], v3 offset:35328
    s_waitcnt lgkmcnt(8)
    v_mfma_f32_32x32x16_bf16 v[8:23], a[52:55], v[44:47], v[8:23]
    buffer_load_dwordx4 v[112:115], v6, s[56:59], s6 offen offset:2048 sc1
    ds_read_b64_tr_b16 v[32:33], v3 offset:36864
    ds_read_b64_tr_b16 v[34:35], v3 offset:37376
    s_waitcnt lgkmcnt(8)
    v_mfma_f32_32x32x16_bf16 v[8:23], a[56:59], v[48:51], v[8:23]
    ds_read_b64_tr_b16 v[36:37], v3 offset:38912
    ds_read_b64_tr_b16 v[38:39], v3 offset:39424
    s_waitcnt lgkmcnt(8)
    v_mfma_f32_32x32x16_bf16 v[8:23], a[60:63], v[52:55], v[8:23]
    ds_read_b64_tr_b16 v[40:41], v3 offset:40960
    ds_read_b64_tr_b16 v[42:43], v3 offset:41472
    s_waitcnt lgkmcnt(8)
    v_mfma_f32_32x32x16_bf16 v[8:23], a[64:67], v[24:27], v[8:23]
    ds_read_b64_tr_b16 v[44:45], v3 offset:43008
    ds_read_b64_tr_b16 v[46:47], v3 offset:43520
    s_waitcnt lgkmcnt(8)
    v_mfma_f32_32x32x16_bf16 v[8:23], a[68:71], v[28:31], v[8:23]
    buffer_load_dwordx4 v[116:119], v6, s[56:59], s6 offen offset:3072 sc1
    ds_read_b64_tr_b16 v[48:49], v3 offset:45056
    ds_read_b64_tr_b16 v[50:51], v3 offset:45568
    s_waitcnt lgkmcnt(8)
    v_mfma_f32_32x32x16_bf16 v[8:23], a[72:75], v[32:35], v[8:23]
    ds_read_b64_tr_b16 v[52:53], v3 offset:47104
    ds_read_b64_tr_b16 v[54:55], v3 offset:47616
    s_waitcnt lgkmcnt(8)
    v_mfma_f32_32x32x16_bf16 v[8:23], a[76:79], v[36:39], v[8:23]
    ds_read_b64_tr_b16 v[24:25], v3 offset:49152
    ds_read_b64_tr_b16 v[26:27], v3 offset:49664
    s_waitcnt lgkmcnt(8)
    v_mfma_f32_32x32x16_bf16 v[8:23], a[80:83], v[40:43], v[8:23]
    ds_read_b64_tr_b16 v[28:29], v3 offset:51200
    ds_read_b64_tr_b16 v[30:31], v3 offset:51712
    s_waitcnt lgkmcnt(8)
    v_mfma_f32_32x32x16_bf16 v[8:23], a[84:87], v[44:47], v[8:23]
    s_mov_b32 s6, 12288
    buffer_load_dwordx4 v[120:123], v6, s[56:59], s6 offen offset:0 sc1
    ds_read_b64_tr_b16 v[32:33], v3 offset:53248
    ds_read_b64_tr_b16 v[34:35], v3 offset:53760
    s_waitcnt lgkmcnt(8)
    v_mfma_f32_32x32x16_bf16 v[8:23], a[88:91], v[48:51], v[8:23]
    ds_read_b64_tr_b16 v[36:37], v3 offset:55296
    ds_read_b64_tr_b16 v[38:39], v3 offset:55808
    s_waitcnt lgkmcnt(8)
    v_mfma_f32_32x32x16_bf16 v[8:23], a[92:95], v[52:55], v[8:23]
    s_waitcnt lgkmcnt(6)
    v_mfma_f32_32x32x16_bf16 v[8:23], a[96:99], v[24:27], v[8:23]
    s_waitcnt lgkmcnt(4)
    v_mfma_f32_32x32x16_bf16 v[8:23], a[100:103], v[28:31], v[8:23]
    buffer_load_dwordx4 v[124:127], v6, s[56:59], s6 offen offset:1024 sc1
    s_waitcnt lgkmcnt(2)
    v_mfma_f32_32x32x16_bf16 v[8:23], a[104:107], v[32:35], v[8:23]
    s_waitcnt lgkmcnt(0)
    v_mfma_f32_32x32x16_bf16 v[8:23], a[108:111], v[36:39], v[8:23]
    s_setprio 0
    s_nop 1
    v_mfma_f32_32x32x16_bf16 v[8:23], v[56:59], v[64:67], v[8:23]
    s_nop 11
    v_mul_f32 v24, v8, v8
    v_mul_f32 v25, v9, v9
    v_mul_f32 v26, v10, v10
    v_mul_f32 v27, v11, v11
    v_fma_f32 v24, v24, v71, v69
    v_fma_f32 v25, v25, v71, v69
    v_fma_f32 v26, v26, v71, v69
    v_fma_f32 v27, v27, v71, v69
    v_mul_f32 v24, v24, v8
    v_mul_f32 v25, v25, v9
    v_mul_f32 v26, v26, v10
    v_mul_f32 v27, v27, v11
    v_exp_f32 v24, v24
    v_exp_f32 v25, v25
    v_exp_f32 v26, v26
    v_exp_f32 v27, v27
    v_fma_f32 v24, v24, v73, v73
    v_fma_f32 v25, v25, v73, v73
    v_fma_f32 v26, v26, v73, v73
    v_fma_f32 v27, v27, v73, v73
    v_rcp_f32 v24, v24
    v_rcp_f32 v25, v25
    v_rcp_f32 v26, v26
    v_rcp_f32 v27, v27
    v_mul_f32 v24, v24, v8
    v_mul_f32 v25, v25, v9
    v_mul_f32 v26, v26, v10
    v_mul_f32 v27, v27, v11
    v_cvt_pk_bf16_f32 v40, v24, v25
    v_cvt_pk_bf16_f32 v41, v26, v27
    v_mul_f32 v28, v12, v12
    v_mul_f32 v29, v13, v13
    v_mul_f32 v30, v14, v14
    v_mul_f32 v31, v15, v15
    v_fma_f32 v28, v28, v71, v69
    v_fma_f32 v29, v29, v71, v69
    v_fma_f32 v30, v30, v71, v69
    v_fma_f32 v31, v31, v71, v69
    v_mul_f32 v28, v28, v12
    v_mul_f32 v29, v29, v13
    v_mul_f32 v30, v30, v14
    v_mul_f32 v31, v31, v15
    v_exp_f32 v28, v28
    v_exp_f32 v29, v29
    v_exp_f32 v30, v30
    v_exp_f32 v31, v31
    v_fma_f32 v28, v28, v73, v73
    v_fma_f32 v29, v29, v73, v73
    v_fma_f32 v30, v30, v73, v73
    v_fma_f32 v31, v31, v73, v73
    v_rcp_f32 v28, v28
    v_rcp_f32 v29, v29
    v_rcp_f32 v30, v30
    v_rcp_f32 v31, v31
    v_mul_f32 v28, v28, v12
    v_mul_f32 v29, v29, v13
    v_mul_f32 v30, v30, v14
    v_mul_f32 v31, v31, v15
    v_cvt_pk_bf16_f32 v42, v28, v29
    v_cvt_pk_bf16_f32 v43, v30, v31
    buffer_store_dwordx4 v[40:43], v4, s[56:59], 0 offen offset:1024 sc1
    v_mul_f32 v24, v16, v16
    v_mul_f32 v25, v17, v17
    v_mul_f32 v26, v18, v18
    v_mul_f32 v27, v19, v19
    v_fma_f32 v24, v24, v71, v69
    v_fma_f32 v25, v25, v71, v69
    v_fma_f32 v26, v26, v71, v69
    v_fma_f32 v27, v27, v71, v69
    v_mul_f32 v24, v24, v16
    v_mul_f32 v25, v25, v17
    v_mul_f32 v26, v26, v18
    v_mul_f32 v27, v27, v19
    v_exp_f32 v24, v24
    v_exp_f32 v25, v25
    v_exp_f32 v26, v26
    v_exp_f32 v27, v27
    v_fma_f32 v24, v24, v73, v73
    v_fma_f32 v25, v25, v73, v73
    v_fma_f32 v26, v26, v73, v73
    v_fma_f32 v27, v27, v73, v73
    v_rcp_f32 v24, v24
    v_rcp_f32 v25, v25
    v_rcp_f32 v26, v26
    v_rcp_f32 v27, v27
    v_mul_f32 v24, v24, v16
    v_mul_f32 v25, v25, v17
    v_mul_f32 v26, v26, v18
    v_mul_f32 v27, v27, v19
    v_cvt_pk_bf16_f32 v44, v24, v25
    v_cvt_pk_bf16_f32 v45, v26, v27
    v_mul_f32 v28, v20, v20
    v_mul_f32 v29, v21, v21
    v_mul_f32 v30, v22, v22
    v_mul_f32 v31, v23, v23
    v_fma_f32 v28, v28, v71, v69
    v_fma_f32 v29, v29, v71, v69
    v_fma_f32 v30, v30, v71, v69
    v_fma_f32 v31, v31, v71, v69
    v_mul_f32 v28, v28, v20
    v_mul_f32 v29, v29, v21
    v_mul_f32 v30, v30, v22
    v_mul_f32 v31, v31, v23
    v_exp_f32 v28, v28
    v_exp_f32 v29, v29
    v_exp_f32 v30, v30
    v_exp_f32 v31, v31
    v_fma_f32 v28, v28, v73, v73
    v_fma_f32 v29, v29, v73, v73
    v_fma_f32 v30, v30, v73, v73
    v_fma_f32 v31, v31, v73, v73
    v_rcp_f32 v28, v28
    v_rcp_f32 v29, v29
    v_rcp_f32 v30, v30
    v_rcp_f32 v31, v31
    v_mul_f32 v28, v28, v20
    v_mul_f32 v29, v29, v21
    v_mul_f32 v30, v30, v22
    v_mul_f32 v31, v31, v23
    v_cvt_pk_bf16_f32 v46, v28, v29
    v_cvt_pk_bf16_f32 v47, v30, v31
    buffer_store_dwordx4 v[44:47], v4, s[56:59], 0 offen offset:3072 sc1
    s_mov_b32 s6, 12288
    buffer_load_dwordx4 a[0:3], v6, s[56:59], s6 offen offset:2048 sc1
    buffer_load_dwordx4 a[4:7], v6, s[56:59], s6 offen offset:3072 sc1
    s_mov_b32 s6, 16384
    buffer_load_dwordx4 a[8:11], v6, s[56:59], s6 offen offset:0 sc1
    buffer_load_dwordx4 a[12:15], v6, s[56:59], s6 offen offset:1024 sc1
    buffer_load_dwordx4 a[16:19], v6, s[56:59], s6 offen offset:2048 sc1
    buffer_load_dwordx4 a[20:23], v6, s[56:59], s6 offen offset:3072 sc1
    s_mov_b32 s6, 20480
    buffer_load_dwordx4 a[24:27], v6, s[56:59], s6 offen offset:0 sc1
    buffer_load_dwordx4 a[28:31], v6, s[56:59], s6 offen offset:1024 sc1
    buffer_load_dwordx4 a[32:35], v6, s[56:59], s6 offen offset:2048 sc1
    buffer_load_dwordx4 a[36:39], v6, s[56:59], s6 offen offset:3072 sc1
    s_mov_b32 s6, 24576
    buffer_load_dwordx4 a[40:43], v6, s[56:59], s6 offen offset:0 sc1
    buffer_load_dwordx4 a[44:47], v6, s[56:59], s6 offen offset:1024 sc1
    buffer_load_dwordx4 a[48:51], v6, s[56:59], s6 offen offset:2048 sc1
    buffer_load_dwordx4 a[52:55], v6, s[56:59], s6 offen offset:3072 sc1
    s_lshl_b32 s4, s74, 13
    s_lshl_b32 s5, s7, 11
    s_add_u32 s4, s4, s5
    v_add_u32 v27, s4, v2
    v_add_u32 v28, s4, v3
    ds_read_b64_tr_b16 v[80:81], v27
    ds_read_b64_tr_b16 v[82:83], v27 offset:512
    ds_read_b64_tr_b16 v[84:85], v28
    ds_read_b64_tr_b16 v[86:87], v28 offset:512
    v_and_b32 v29, 31, v1
    v_lshrrev_b32 v30, 5, v1
    v_lshlrev_b32 v30, 3, v30
    v_sub_u32 v29, v29, v30
    s_lshl_b32 s4, s7, 4
    v_subrev_u32 v29, s4, v29
    v_add_u32 v33, 32, v29
    v_mov_b32 v31, 0x3f80
    v_mov_b32 v32, 0x3f800000
    v_cmp_eq_u32 vcc, 0, v29
    v_cmp_eq_u32 s[4:5], 1, v29
    s_nop 1
    v_cndmask_b32 v72, 0, v31, vcc
    v_cndmask_b32 v72, v72, v32, s[4:5]
    v_cmp_eq_u32 vcc, 2, v29
    v_cmp_eq_u32 s[4:5], 3, v29
    s_nop 1
    v_cndmask_b32 v73, 0, v31, vcc
    v_cndmask_b32 v73, v73, v32, s[4:5]
    v_cmp_eq_u32 vcc, 4, v29
    v_cmp_eq_u32 s[4:5], 5, v29
    s_nop 1
    v_cndmask_b32 v74, 0, v31, vcc
    v_cndmask_b32 v74, v74, v32, s[4:5]
    v_cmp_eq_u32 vcc, 6, v29
    v_cmp_eq_u32 s[4:5], 7, v29
    s_nop 1
    v_cndmask_b32 v75, 0, v31, vcc
    v_cndmask_b32 v75, v75, v32, s[4:5]
    v_cmp_eq_u32 vcc, 0, v33
    v_cmp_eq_u32 s[4:5], 1, v33
    s_nop 1
    v_cndmask_b32 v76, 0, v31, vcc
    v_cndmask_b32 v76, v76, v32, s[4:5]
    v_cmp_eq_u32 vcc, 2, v33
    v_cmp_eq_u32 s[4:5], 3, v33
    s_nop 1
    v_cndmask_b32 v77, 0, v31, vcc
    v_cndmask_b32 v77, v77, v32, s[4:5]
    v_cmp_eq_u32 vcc, 4, v33
    v_cmp_eq_u32 s[4:5], 5, v33
    s_nop 1
    v_cndmask_b32 v78, 0, v31, vcc
    v_cndmask_b32 v78, v78, v32, s[4:5]
    v_cmp_eq_u32 vcc, 6, v33
    v_cmp_eq_u32 s[4:5], 7, v33
    s_nop 1
    v_cndmask_b32 v79, 0, v31, vcc
    v_cndmask_b32 v79, v79, v32, s[4:5]
    s_waitcnt lgkmcnt(0)
    s_nop 1
    v_mfma_f32_32x32x16_bf16 v[8:23], v[72:75], v[80:83], 0
    v_mfma_f32_32x32x16_bf16 v[24:39], v[72:75], v[84:87], 0
    v_mfma_f32_32x32x16_bf16 v[40:55], v[76:79], v[80:83], 0
    v_mfma_f32_32x32x16_bf16 v[56:71], v[76:79], v[84:87], 0
    s_waitcnt vmcnt(14)
    s_cmp_eq_u32 s3, 4
    s_cbranch_scc0 A_NOB2
    v_cmp_gt_u32 vcc, 32, v1
    v_mov_b32 v73, 0
    v_mov_b32 v74, 0
    v_mov_b32 v75, 0
    v_mov_b32 v76, 0
    v_mov_b32 v77, 0
    v_mov_b32 v78, 0
    v_mov_b32 v79, 0
    v_mov_b32 v80, 0
    v_mov_b32 v81, 0
    v_mov_b32 v82, 0
    v_mov_b32 v83, 0
    v_cndmask_b32 v72, 0, v5, vcc
    v_cndmask_b32 v76, 0, v7, vcc
    v_mov_b32 v80, 0x3f80
    s_nop 1
    v_mfma_f32_32x32x16_bf16 v[8:23], v[72:75], v[80:83], v[8:23]
    v_mfma_f32_32x32x16_bf16 v[24:39], v[72:75], v[80:83], v[24:39]
    v_mfma_f32_32x32x16_bf16 v[40:55], v[76:79], v[80:83], v[40:55]
    v_mfma_f32_32x32x16_bf16 v[56:71], v[76:79], v[80:83], v[56:71]
A_NOB2:
    s_mul_i32 s4, s73, 112
    s_mul_i32 s5, s61, 14
    s_add_u32 s4, s4, s5
    s_lshl_b32 s4, s4, 11
    s_add_u32 s4, s4, 8863744
    v_lshl_add_u32 v4, v1, 4, s4
    v_and_b32 v3, 31, v1
    v_lshrrev_b32 v5, 5, v1
    v_and_b32 v2, 7, v1
    v_xor_b32 v5, v5, v2
    v_lshlrev_b32 v5, 4, v5
    v_lshl_add_u32 v3, v3, 8, v5
    s_lshl_b32 s5, s3, 14
    v_add_u32 v3, s5, v3
    s_lshl_b32 s4, s73, 8
    s_add_u32 s4, s4, 18432
    v_mov_b32 v5, s4
    s_barrier
    s_cmp_eq_u32 s3, 6
    s_cbranch_scc0 S3_WAIT
    s_mov_b32 s5, 1
    s_atomic_add s5, s[56:57], s4
    s_mov_b32 s77, 262144
POLL_28:
    buffer_load_dword v7, v5, s[56:59], 0 offen sc1
    s_waitcnt vmcnt(0)
    v_readfirstlane_b32 s75, v7
    s_cmp_ge_u32 s75, 7
    s_cbranch_scc1 POLLD_29
    s_sub_u32 s77, s77, 1
    s_cbranch_scc0 POLL_28
    v_mov_b32 v7, 83
    v_mov_b32 v5, 4
    buffer_store_dword v7, v5, s[52:55], 0 offen
POLLD_29:
S3_WAIT:
    s_barrier
    s_mov_b32 s4, 0
    buffer_load_dwordx4 a[56:59], v4, s[56:59], s4 offen offset:0 sc1
    buffer_load_dwordx4 a[60:63], v4, s[56:59], s4 offen offset:1024 sc1
    buffer_load_dwordx4 a[64:67], v4, s[56:59], s4 offen offset:2048 sc1
    buffer_load_dwordx4 a[68:71], v4, s[56:59], s4 offen offset:3072 sc1
    s_mov_b32 s4, 4096
    buffer_load_dwordx4 a[72:75], v4, s[56:59], s4 offen offset:0 sc1
    buffer_load_dwordx4 a[76:79], v4, s[56:59], s4 offen offset:1024 sc1
    buffer_load_dwordx4 a[80:83], v4, s[56:59], s4 offen offset:2048 sc1
    buffer_load_dwordx4 a[84:87], v4, s[56:59], s4 offen offset:3072 sc1
    s_mov_b32 s4, 8192
    buffer_load_dwordx4 a[88:91], v4, s[56:59], s4 offen offset:0 sc1
    buffer_load_dwordx4 a[92:95], v4, s[56:59], s4 offen offset:1024 sc1
    buffer_load_dwordx4 a[96:99], v4, s[56:59], s4 offen offset:2048 sc1
    buffer_load_dwordx4 a[100:103], v4, s[56:59], s4 offen offset:3072 sc1
    s_mov_b32 s4, 12288
    buffer_load_dwordx4 a[104:107], v4, s[56:59], s4 offen offset:0 sc1
    buffer_load_dwordx4 a[108:111], v4, s[56:59], s4 offen offset:1024 sc1
    buffer_load_dwordx4 v[72:75], v4, s[56:59], s4 offen offset:2048 sc1
    buffer_load_dwordx4 v[76:79], v4, s[56:59], s4 offen offset:3072 sc1
    s_mov_b32 s4, 16384
    buffer_load_dwordx4 v[80:83], v4, s[56:59], s4 offen offset:0 sc1
    buffer_load_dwordx4 v[84:87], v4, s[56:59], s4 offen offset:1024 sc1
    s_waitcnt vmcnt(16)
    v_mfma_f32_32x32x16_bf16 v[8:23], a[112:115], a[56:59], v[8:23]
    v_mfma_f32_32x32x16_bf16 v[40:55], a[116:119], a[56:59], v[40:55]
    v_mfma_f32_32x32x16_bf16 v[24:39], a[112:115], a[60:63], v[24:39]
    v_mfma_f32_32x32x16_bf16 v[56:71], a[116:119], a[60:63], v[56:71]
    s_mov_b32 s4, 16384
    buffer_load_dwordx4 a[56:59], v4, s[56:59], s4 offen offset:2048 sc1
    buffer_load_dwordx4 a[60:63], v4, s[56:59], s4 offen offset:3072 sc1
    s_waitcnt vmcnt(16)
    v_mfma_f32_32x32x16_bf16 v[8:23], a[120:123], a[64:67], v[8:23]
    v_mfma_f32_32x32x16_bf16 v[40:55], a[124:127], a[64:67], v[40:55]
    v_mfma_f32_32x32x16_bf16 v[24:39], a[120:123], a[68:71], v[24:39]
    v_mfma_f32_32x32x16_bf16 v[56:71], a[124:127], a[68:71], v[56:71]
    s_mov_b32 s4, 20480
    buffer_load_dwordx4 a[64:67], v4, s[56:59], s4 offen offset:0 sc1
    buffer_load_dwordx4 a[68:71], v4, s[56:59], s4 offen offset:1024 sc1
    s_waitcnt vmcnt(16)
    v_mfma_f32_32x32x16_bf16 v[8:23], v[88:91], a[72:75], v[8:23]
    v_mfma_f32_32x32x16_bf16 v[40:55], v[92:95], a[72:75], v[40:55]
    v_mfma_f32_32x32x16_bf16 v[24:39], v[88:91], a[76:79], v[24:39]
    v_mfma_f32_32x32x16_bf16 v[56:71], v[92:95], a[76:79], v[56:71]
    buffer_load_dwordx4 a[72:75], v4, s[56:59], s4 offen offset:2048 sc1
    buffer_load_dwordx4 a[76:79], v4, s[56:59], s4 offen offset:3072 sc1
    s_waitcnt vmcnt(16)
    v_mfma_f32_32x32x16_bf16 v[8:23], v[96:99], a[80:83], v[8:23]
    v_mfma_f32_32x32x16_bf16 v[40:55], v[100:103], a[80:83], v[40:55]
    v_mfma_f32_32x32x16_bf16 v[24:39], v[96:99], a[84:87], v[24:39]
    v_mfma_f32_32x32x16_bf16 v[56:71], v[100:103], a[84:87], v[56:71]
    s_mov_b32 s4, 24576
    buffer_load_dwordx4 a[80:83], v4, s[56:59], s4 offen offset:0 sc1
    buffer_load_dwordx4 a[84:87], v4, s[56:59], s4 offen offset:1024 sc1
    s_waitcnt vmcnt(16)
    v_mfma_f32_32x32x16_bf16 v[8:23], v[104:107], a[88:91], v[8:23]
    v_mfma_f32_32x32x16_bf16 v[40:55], v[108:111], a[88:91], v[40:55]
    v_mfma_f32_32x32x16_bf16 v[24:39], v[104:107], a[92:95], v[24:39]
    v_mfma_f32_32x32x16_bf16 v[56:71], v[108:111], a[92:95], v[56:71]
    buffer_load_dwordx4 a[88:91], v4, s[56:59], s4 offen offset:2048 sc1
    buffer_load_dwordx4 a[92:95], v4, s[56:59], s4 offen offset:3072 sc1
    s_barrier
    s_waitcnt vmcnt(16)
    v_mfma_f32_32x32x16_bf16 v[8:23], v[112:115], a[96:99], v[8:23]
    v_mfma_f32_32x32x16_bf16 v[40:55], v[116:119], a[96:99], v[40:55]
    v_mfma_f32_32x32x16_bf16 v[24:39], v[112:115], a[100:103], v[24:39]
    v_mfma_f32_32x32x16_bf16 v[56:71], v[116:119], a[100:103], v[56:71]
    s_waitcnt vmcnt(14)
    v_mfma_f32_32x32x16_bf16 v[8:23], v[120:123], a[104:107], v[8:23]
    v_mfma_f32_32x32x16_bf16 v[40:55], v[124:127], a[104:107], v[40:55]
    v_mfma_f32_32x32x16_bf16 v[24:39], v[120:123], a[108:111], v[24:39]
    v_mfma_f32_32x32x16_bf16 v[56:71], v[124:127], a[108:111], v[56:71]
    s_waitcnt vmcnt(12)
    v_mfma_f32_32x32x16_bf16 v[8:23], a[0:3], v[72:75], v[8:23]
    v_mfma_f32_32x32x16_bf16 v[40:55], a[4:7], v[72:75], v[40:55]
    v_mfma_f32_32x32x16_bf16 v[24:39], a[0:3], v[76:79], v[24:39]
    v_mfma_f32_32x32x16_bf16 v[56:71], a[4:7], v[76:79], v[56:71]
    s_waitcnt vmcnt(10)
    v_mfma_f32_32x32x16_bf16 v[8:23], a[8:11], v[80:83], v[8:23]
    v_mfma_f32_32x32x16_bf16 v[40:55], a[12:15], v[80:83], v[40:55]
    v_mfma_f32_32x32x16_bf16 v[24:39], a[8:11], v[84:87], v[24:39]
    v_mfma_f32_32x32x16_bf16 v[56:71], a[12:15], v[84:87], v[56:71]
    s_waitcnt vmcnt(8)
    v_mfma_f32_32x32x16_bf16 v[8:23], a[16:19], a[56:59], v[8:23]
    v_mfma_f32_32x32x16_bf16 v[40:55], a[20:23], a[56:59], v[40:55]
    v_mfma_f32_32x32x16_bf16 v[24:39], a[16:19], a[60:63], v[24:39]
    v_mfma_f32_32x32x16_bf16 v[56:71], a[20:23], a[60:63], v[56:71]
    s_waitcnt vmcnt(6)
    v_mfma_f32_32x32x16_bf16 v[8:23], a[24:27], a[64:67], v[8:23]
    v_mfma_f32_32x32x16_bf16 v[40:55], a[28:31], a[64:67], v[40:55]
    v_mfma_f32_32x32x16_bf16 v[24:39], a[24:27], a[68:71], v[24:39]
    v_mfma_f32_32x32x16_bf16 v[56:71], a[28:31], a[68:71], v[56:71]
    s_waitcnt vmcnt(4)
    v_mfma_f32_32x32x16_bf16 v[8:23], a[32:35], a[72:75], v[8:23]
    v_mfma_f32_32x32x16_bf16 v[40:55], a[36:39], a[72:75], v[40:55]
    v_mfma_f32_32x32x16_bf16 v[24:39], a[32:35], a[76:79], v[24:39]
    v_mfma_f32_32x32x16_bf16 v[56:71], a[36:39], a[76:79], v[56:71]
    s_waitcnt vmcnt(2)
    v_mfma_f32_32x32x16_bf16 v[8:23], a[40:43], a[80:83], v[8:23]
    v_mfma_f32_32x32x16_bf16 v[40:55], a[44:47], a[80:83], v[40:55]
    v_mfma_f32_32x32x16_bf16 v[24:39], a[40:43], a[84:87], v[24:39]
    v_mfma_f32_32x32x16_bf16 v[56:71], a[44:47], a[84:87], v[56:71]
    s_waitcnt vmcnt(0)
    v_mfma_f32_32x32x16_bf16 v[8:23], a[48:51], a[88:91], v[8:23]
    v_mfma_f32_32x32x16_bf16 v[40:55], a[52:55], a[88:91], v[40:55]
    v_mfma_f32_32x32x16_bf16 v[24:39], a[48:51], a[92:95], v[24:39]
    v_mfma_f32_32x32x16_bf16 v[56:71], a[52:55], a[92:95], v[56:71]
G2_WR:
    v_xor_b32 v72, 32, v3
    v_xor_b32 v73, 64, v3
    v_xor_b32 v74, 0x60, v3
    v_lshrrev_b32 v2, 3, v0
    v_and_b32 v7, 7, v0
    v_mul_u32_u24 v6, 896, v2
    v_lshl_add_u32 v6, v7, 4, v6
    s_mul_i32 s4, s73, 57344
    s_lshl_b32 s5, s74, 7
    s_add_u32 s4, s4, s5
    v_add_u32 v6, s4, v6
    v_lshlrev_b32 v7, 1, v7
    ds_write_b128 v3, v[8:11] offset:0
    ds_write_b128 v72, v[12:15] offset:0
    ds_write_b128 v73, v[16:19] offset:0
    ds_write_b128 v74, v[20:23] offset:0
    ds_write_b128 v3, v[40:43] offset:128
    ds_write_b128 v72, v[44:47] offset:128
    ds_write_b128 v73, v[48:51] offset:128
    ds_write_b128 v74, v[52:55] offset:128
    ds_write_b128 v3, v[24:27] offset:8192
    ds_write_b128 v72, v[28:31] offset:8192
    ds_write_b128 v73, v[32:35] offset:8192
    ds_write_b128 v74, v[36:39] offset:8192
    ds_write_b128 v3, v[56:59] offset:8320
    ds_write_b128 v72, v[60:63] offset:8320
    ds_write_b128 v73, v[64:67] offset:8320
    ds_write_b128 v74, v[68:71] offset:8320
    v_and_b32 v5, 7, v2
    v_xor_b32 v5, v5, v7
    v_lshlrev_b32 v5, 4, v5
    v_lshl_add_u32 v5, v2, 8, v5
    v_xor_b32 v7, 16, v5
    v_add_u32 v75, 0x10000, v5
    v_add_u32 v76, 0x10000, v7
    s_waitcnt lgkmcnt(0)
    s_barrier
    ds_read_b128 v[8:11], v5 offset:0
    ds_read_b128 v[12:15], v7 offset:0
    ds_read_b128 v[16:19], v5 offset:16384
    ds_read_b128 v[20:23], v7 offset:16384
    ds_read_b128 v[24:27], v5 offset:32768
    ds_read_b128 v[28:31], v7 offset:32768
    ds_read_b128 v[32:35], v5 offset:49152
    ds_read_b128 v[36:39], v7 offset:49152
    ds_read_b128 v[40:43], v75 offset:0
    ds_read_b128 v[44:47], v76 offset:0
    ds_read_b128 v[48:51], v75 offset:16384
    ds_read_b128 v[52:55], v76 offset:16384
    ds_read_b128 v[56:59], v75 offset:32768
    ds_read_b128 v[60:63], v76 offset:32768
    ds_read_b128 v[64:67], v75 offset:49152
    ds_read_b128 v[68:71], v76 offset:49152
    s_waitcnt lgkmcnt(12)
    v_pk_add_f32 v[8:9], v[8:9], v[16:17]
    v_pk_add_f32 v[10:11], v[10:11], v[18:19]
    v_pk_add_f32 v[12:13], v[12:13], v[20:21]
    v_pk_add_f32 v[14:15], v[14:15], v[22:23]
    s_waitcnt lgkmcnt(10)
    v_pk_add_f32 v[8:9], v[8:9], v[24:25]
    v_pk_add_f32 v[10:11], v[10:11], v[26:27]
    v_pk_add_f32 v[12:13], v[12:13], v[28:29]
    v_pk_add_f32 v[14:15], v[14:15], v[30:31]
    s_waitcnt lgkmcnt(8)
    v_pk_add_f32 v[8:9], v[8:9], v[32:33]
    v_pk_add_f32 v[10:11], v[10:11], v[34:35]
    v_pk_add_f32 v[12:13], v[12:13], v[36:37]
    v_pk_add_f32 v[14:15], v[14:15], v[38:39]
    s_waitcnt lgkmcnt(6)
    v_pk_add_f32 v[8:9], v[8:9], v[40:41]
    v_pk_add_f32 v[10:11], v[10:11], v[42:43]
    v_pk_add_f32 v[12:13], v[12:13], v[44:45]
    v_pk_add_f32 v[14:15], v[14:15], v[46:47]
    s_waitcnt lgkmcnt(4)
    v_pk_add_f32 v[8:9], v[8:9], v[48:49]
    v_pk_add_f32 v[10:11], v[10:11], v[50:51]
    v_pk_add_f32 v[12:13], v[12:13], v[52:53]
    v_pk_add_f32 v[14:15], v[14:15], v[54:55]
    s_waitcnt lgkmcnt(2)
    v_pk_add_f32 v[8:9], v[8:9], v[56:57]
    v_pk_add_f32 v[10:11], v[10:11], v[58:59]
    v_pk_add_f32 v[12:13], v[12:13], v[60:61]
    v_pk_add_f32 v[14:15], v[14:15], v[62:63]
    s_waitcnt lgkmcnt(0)
    v_pk_add_f32 v[8:9], v[8:9], v[64:65]
    v_pk_add_f32 v[10:11], v[10:11], v[66:67]
    v_pk_add_f32 v[12:13], v[12:13], v[68:69]
    v_pk_add_f32 v[14:15], v[14:15], v[70:71]
    v_cvt_pk_bf16_f32 v40, v8, v9
    v_cvt_pk_bf16_f32 v41, v10, v11
    v_cvt_pk_bf16_f32 v42, v12, v13
    v_cvt_pk_bf16_f32 v43, v14, v15
    buffer_store_dwordx4 v[40:43], v6, s[48:51], 0 offen
FINISH:
EXIT:
    s_endpgm
CODE_END:
.section .rodata,"a"
.p2align 6
.amdhsa_kernel sequential_preLN__ssm_conv_h3__mixer_channel_mlp__prompt_kernel
  .amdhsa_next_free_vgpr 256
  .amdhsa_next_free_sgpr 102
  .amdhsa_accum_offset 128
  .amdhsa_group_segment_fixed_size 0
  .amdhsa_kernarg_size 112
  .amdhsa_user_sgpr_count 2
  .amdhsa_user_sgpr_kernarg_segment_ptr 1
  .amdhsa_system_sgpr_workgroup_id_x 1
.end_amdhsa_kernel
```
